```python
import torch

def _softmax(x, axis=-1):
    return torch.softmax(x, dim=axis)
def _gelu(x):
    return torch.nn.functional.gelu(x, approximate="tanh")
def _silu(x):
    return torch.nn.functional.silu(x)
def _sigmoid(x):
    return torch.sigmoid(x)
def _layernorm(x, axis=-1, eps=1e-5):
    m = x.mean(dim=axis, keepdim=True)
    v = x.var(dim=axis, keepdim=True, unbiased=False)
    return (x - m) / torch.sqrt(v + eps)
def _scatter_add(tgt, idx, src, axis=0):
    return tgt.clone().index_add_(axis, idx, src)
def _segment_sum(src, seg, n):
    out = torch.zeros((n,) + src.shape[1:], dtype=src.dtype)
    return out.index_add_(0, seg, src)
def _pad(x, pw):
    flat = tuple(v for pair in reversed(pw) for v in pair)
    return torch.nn.functional.pad(x, flat)

kernel_name = 'gather_scatter__cheap_equivariant_egnn__graph'

def setup_inputs():

    _w = (lambda a: (lambda t: t.to(torch.bfloat16) if t.is_floating_point() else t)(torch.as_tensor(a)))
    N, deg, D, De = 12500, 64, 64, max(16, 1)
    E = N * deg
    return {
        "h": _w((lambda *s: torch.randn(*s, dtype=torch.bfloat16) * 0.1)(N, D)),
        "pos": _w((lambda *s: torch.randn(*s, dtype=torch.bfloat16) * 0.8)(N, 3)),
        "e_attr": _w((lambda *s: torch.randn(*s, dtype=torch.bfloat16) * 0.8)(E, De)),
        "src": _w((lambda lo, hi, *s: torch.randint(lo, hi, s))(0, N, E).to(torch.int64)),
        "dst": _w((lambda lo, hi, *s: torch.randint(lo, hi, s))(0, N, E).to(torch.int64)),
        "w_e": _w(0.1 * (lambda *s: torch.randn(*s, dtype=torch.bfloat16) * 0.8)(2 * D + 1 + De, D)),
        "w_x": _w(0.1 * (lambda *s: torch.randn(*s, dtype=torch.bfloat16) * 0.1)(D, 1)),
        "w_h": _w(0.1 * (lambda *s: torch.randn(*s, dtype=torch.bfloat16) * 0.1)(2 * D, D)),
    }

def reference(h, pos, e_attr, src, dst, w_e, w_x, w_h):
    N, D = h.shape[0], h.shape[1]
    diff = pos[dst] - pos[src]
    dist2 = torch.sum(diff * diff, axis=-1, keepdims=True)
    e_in = torch.concatenate([h[dst], h[src], dist2, e_attr], axis=-1)
    m_ij = _silu(e_in @ w_e)
    coord_scale = m_ij @ w_x
    pos_new = pos + _segment_sum(diff * coord_scale, dst, N)
    m_i = _segment_sum(m_ij, dst, N)
    h_new = h + _silu(torch.concatenate([h, m_i], axis=-1) @ w_h)
    return h_new, pos_new
```

```asm
; @launch kernel=egnn_part_kernel grid=(349,1,1) block=(512,1,1) lds=32832
; @launch kernel=egnn_main_kernel grid=(256,1,1) block=(512,1,1) lds=162816
.amdgcn_target "amdgcn-amd-amdhsa--gfx950"
.text
.globl egnn_part_kernel
.p2align 8
.type egnn_part_kernel,@function
egnn_part_kernel:
    s_cmp_gt_u32 s2, 348
    s_cbranch_scc1 L1_end
    v_lshrrev_b32 v2, 6, v0
    v_and_b32 v1, 63, v0
    s_load_dwordx4 s[4:7], s[0:1], 24
    s_load_dwordx2 s[8:9], s[0:1], 80
    s_load_dwordx2 s[34:35], s[0:1], 16
    v_readfirstlane_b32 s3, v2
    s_cmp_eq_u32 s2, 250
    s_cbranch_scc1 L1_wprep
    s_cmp_gt_u32 s2, 250
    s_cbranch_scc1 L1_tables
    s_sub_u32 s38, s2, 0
    s_setprio 3
    v_lshlrev_b32 v3, 4, v0
    v_mov_b32 v4, 0
    v_mov_b32 v5, 0
    v_mov_b32 v6, 0
    v_mov_b32 v7, 0
    ds_write_b128 v3, v[4:7]
    s_mul_i32 s10, s38, 12800
    s_mul_i32 s11, s38, 4224
    v_add_u32 v48, 8192, v3
    s_waitcnt lgkmcnt(0)
    s_add_u32 s12, s6, s10
    s_addc_u32 s13, s7, 0
    s_mov_b32 s14, 12800
    s_mov_b32 s15, 0x20000
    s_add_u32 s16, s4, s10
    s_addc_u32 s17, s5, 0
    s_mov_b32 s18, 12800
    s_mov_b32 s19, 0x20000
    buffer_load_dwordx4 v[8:11], v3, s[12:15], 0 offen
    buffer_load_dwordx4 v[12:15], v48, s[12:15], 0 offen
    buffer_load_dwordx4 v[16:19], v3, s[16:19], 0 offen
    buffer_load_dwordx4 v[20:23], v48, s[16:19], 0 offen
    s_add_u32 s24, s8, 0
    s_addc_u32 s25, s9, 0
    s_add_u32 s24, s24, s11
    s_addc_u32 s25, s25, 0
    s_mov_b32 s26, 4224
    s_mov_b32 s27, 0x20000
    s_add_u32 s28, s8, 1114112
    s_addc_u32 s29, s9, 0
    s_add_u32 s28, s28, s10
    s_addc_u32 s29, s29, 0
    s_mov_b32 s30, 12800
    s_mov_b32 s31, 0x20000
    s_mov_b32 s22, -49
    v_mov_b32 v50, 1
    v_lshlrev_b32 v51, 5, v0
    v_add_u32 v52, 16384, v51
    s_barrier
    s_waitcnt vmcnt(2)
    v_mul_u32_u24 v54, 21400, v8
    v_lshrrev_b32 v54, 20, v54
    v_mad_i32_i24 v40, v54, s22, v8
    v_and_b32 v55, 7, v40
    v_lshl_or_b32 v54, v54, 3, v55
    v_lshlrev_b32 v24, 2, v54
    ds_add_rtn_u32 v32, v24, v50
    v_mul_u32_u24 v56, 21400, v9
    v_lshrrev_b32 v56, 20, v56
    v_mad_i32_i24 v41, v56, s22, v9
    v_and_b32 v57, 7, v41
    v_lshl_or_b32 v56, v56, 3, v57
    v_lshlrev_b32 v25, 2, v56
    ds_add_rtn_u32 v33, v25, v50
    v_mul_u32_u24 v58, 21400, v10
    v_lshrrev_b32 v58, 20, v58
    v_mad_i32_i24 v42, v58, s22, v10
    v_and_b32 v59, 7, v42
    v_lshl_or_b32 v58, v58, 3, v59
    v_lshlrev_b32 v26, 2, v58
    ds_add_rtn_u32 v34, v26, v50
    v_mul_u32_u24 v60, 21400, v11
    v_lshrrev_b32 v60, 20, v60
    v_mad_i32_i24 v43, v60, s22, v11
    v_and_b32 v61, 7, v43
    v_lshl_or_b32 v60, v60, 3, v61
    v_lshlrev_b32 v27, 2, v60
    ds_add_rtn_u32 v35, v27, v50
    v_cmp_gt_u32 vcc, 288, v0
    s_and_saveexec_b64 s[20:21], vcc
    s_cbranch_execz L1_skipB1
    v_mul_u32_u24 v54, 21400, v12
    v_lshrrev_b32 v54, 20, v54
    v_mad_i32_i24 v44, v54, s22, v12
    v_and_b32 v55, 7, v44
    v_lshl_or_b32 v54, v54, 3, v55
    v_lshlrev_b32 v28, 2, v54
    ds_add_rtn_u32 v36, v28, v50
    v_mul_u32_u24 v56, 21400, v13
    v_lshrrev_b32 v56, 20, v56
    v_mad_i32_i24 v45, v56, s22, v13
    v_and_b32 v57, 7, v45
    v_lshl_or_b32 v56, v56, 3, v57
    v_lshlrev_b32 v29, 2, v56
    ds_add_rtn_u32 v37, v29, v50
    v_mul_u32_u24 v58, 21400, v14
    v_lshrrev_b32 v58, 20, v58
    v_mad_i32_i24 v46, v58, s22, v14
    v_and_b32 v59, 7, v46
    v_lshl_or_b32 v58, v58, 3, v59
    v_lshlrev_b32 v30, 2, v58
    ds_add_rtn_u32 v38, v30, v50
    v_mul_u32_u24 v60, 21400, v15
    v_lshrrev_b32 v60, 20, v60
    v_mad_i32_i24 v47, v60, s22, v15
    v_and_b32 v61, 7, v47
    v_lshl_or_b32 v60, v60, 3, v61
    v_lshlrev_b32 v31, 2, v60
    ds_add_rtn_u32 v39, v31, v50
L1_skipB1:
    s_mov_b64 exec, s[20:21]
    s_waitcnt vmcnt(0)
    v_lshrrev_b32 v54, 3, v40
    v_lshl_or_b32 v54, v40, 29, v54
    v_lshl_or_b32 v54, v16, 15, v54
    v_add3_u32 v40, v54, v51, 0
    v_lshrrev_b32 v54, 3, v41
    v_lshl_or_b32 v54, v41, 29, v54
    v_lshl_or_b32 v54, v17, 15, v54
    v_add3_u32 v41, v54, v51, 8
    v_lshrrev_b32 v54, 3, v42
    v_lshl_or_b32 v54, v42, 29, v54
    v_lshl_or_b32 v54, v18, 15, v54
    v_add3_u32 v42, v54, v51, 16
    v_lshrrev_b32 v54, 3, v43
    v_lshl_or_b32 v54, v43, 29, v54
    v_lshl_or_b32 v54, v19, 15, v54
    v_add3_u32 v43, v54, v51, 24
    v_lshrrev_b32 v54, 3, v44
    v_lshl_or_b32 v54, v44, 29, v54
    v_lshl_or_b32 v54, v20, 15, v54
    v_add3_u32 v44, v54, v52, 0
    v_lshrrev_b32 v54, 3, v45
    v_lshl_or_b32 v54, v45, 29, v54
    v_lshl_or_b32 v54, v21, 15, v54
    v_add3_u32 v45, v54, v52, 8
    v_lshrrev_b32 v54, 3, v46
    v_lshl_or_b32 v54, v46, 29, v54
    v_lshl_or_b32 v54, v22, 15, v54
    v_add3_u32 v46, v54, v52, 16
    v_lshrrev_b32 v54, 3, v47
    v_lshl_or_b32 v54, v47, 29, v54
    v_lshl_or_b32 v54, v23, 15, v54
    v_add3_u32 v47, v54, v52, 24
    s_waitcnt lgkmcnt(0)
    s_barrier
    ds_read_b128 v[8:11], v3
    s_waitcnt lgkmcnt(0)
    v_add_u32 v12, v8, v9
    v_add_u32 v13, v12, v10
    v_add_u32 v14, v13, v11
    v_mov_b32 v15, v14
    s_nop 1
    v_add_u32_dpp v15, v15, v15 row_shr:1 row_mask:0xf bank_mask:0xf
    s_nop 1
    v_add_u32_dpp v15, v15, v15 row_shr:2 row_mask:0xf bank_mask:0xf
    s_nop 1
    v_add_u32_dpp v15, v15, v15 row_shr:4 row_mask:0xf bank_mask:0xf
    s_nop 1
    v_add_u32_dpp v15, v15, v15 row_shr:8 row_mask:0xf bank_mask:0xf
    s_nop 1
    v_add_u32_dpp v15, v15, v15 row_bcast:15 row_mask:0xa bank_mask:0xf
    s_nop 1
    v_add_u32_dpp v15, v15, v15 row_bcast:31 row_mask:0xc bank_mask:0xf
    s_lshl_b32 s10, s3, 2
    s_add_u32 s10, s10, 24576
    v_mov_b32 v16, s10
    s_mov_b32 s20, 0
    s_brev_b32 s21, 1
    s_mov_b64 exec, s[20:21]
    ds_write_b32 v16, v15
    s_mov_b64 exec, -1
    v_and_b32 v17, 7, v1
    v_lshlrev_b32 v17, 2, v17
    v_add_u32 v17, 24576, v17
    s_waitcnt lgkmcnt(0)
    s_barrier
    ds_read_b32 v18, v17
    v_cmp_gt_u32 vcc, s3, v1
    s_waitcnt lgkmcnt(0)
    s_nop 0
    v_cndmask_b32 v18, 0, v18, vcc
    s_nop 1
    v_add_u32_dpp v18, v18, v18 row_shr:1 row_mask:0xf bank_mask:0xf
    s_nop 1
    v_add_u32_dpp v18, v18, v18 row_shr:2 row_mask:0xf bank_mask:0xf
    s_nop 1
    v_add_u32_dpp v18, v18, v18 row_shr:4 row_mask:0xf bank_mask:0xf
    s_nop 0
    v_readlane_b32 s10, v18, 7
    v_sub_u32 v15, v15, v14
    s_nop 0
    v_add_u32 v19, s10, v15
    v_add_u32 v21, v19, v12
    v_add_u32 v22, v19, v13
    v_add_u32 v20, v19, v8
    v_mov_b32 v56, v19
    v_mov_b32 v57, v20
    v_mov_b32 v58, v21
    v_mov_b32 v59, v22
    ds_write_b128 v3, v[56:59]
    v_lshl_or_b32 v60, v20, 16, v19
    v_lshl_or_b32 v61, v22, 16, v21
    v_lshlrev_b32 v62, 3, v0
    buffer_store_dwordx2 v[60:61], v62, s[24:27], 0 offen sc1
    s_cmp_lg_u32 s3, 0
    s_cbranch_scc1 L1_nosent
    s_mov_b32 s10, 209718400
    v_mov_b32 v63, s10
    v_lshlrev_b32 v62, 2, v1
    v_add_u32 v62, 4096, v62
    v_cmp_gt_u32 vcc, 32, v1
    s_and_saveexec_b64 s[20:21], vcc
    buffer_store_dword v63, v62, s[24:27], 0 offen sc1
    s_mov_b64 exec, s[20:21]
L1_nosent:
    s_waitcnt lgkmcnt(0)
    s_barrier
    ds_read_b32 v8, v24
    ds_read_b32 v9, v25
    ds_read_b32 v10, v26
    ds_read_b32 v11, v27
    v_cmp_gt_u32 vcc, 288, v0
    s_and_saveexec_b64 s[20:21], vcc
    s_cbranch_execz L1_skipB2
    ds_read_b32 v12, v28
    ds_read_b32 v13, v29
    ds_read_b32 v14, v30
    ds_read_b32 v15, v31
    s_waitcnt lgkmcnt(0)
    v_add_lshl_u32 v12, v12, v36, 2
    v_add_lshl_u32 v13, v13, v37, 2
    v_add_lshl_u32 v14, v14, v38, 2
    v_add_lshl_u32 v15, v15, v39, 2
    ds_write_b32 v12, v44 offset:8192
    ds_write_b32 v13, v45 offset:8192
    ds_write_b32 v14, v46 offset:8192
    ds_write_b32 v15, v47 offset:8192
L1_skipB2:
    s_mov_b64 exec, s[20:21]
    s_waitcnt lgkmcnt(0)
    v_add_lshl_u32 v8, v8, v32, 2
    v_add_lshl_u32 v9, v9, v33, 2
    v_add_lshl_u32 v10, v10, v34, 2
    v_add_lshl_u32 v11, v11, v35, 2
    ds_write_b32 v8, v40 offset:8192
    ds_write_b32 v9, v41 offset:8192
    ds_write_b32 v10, v42 offset:8192
    ds_write_b32 v11, v43 offset:8192
    s_waitcnt lgkmcnt(0)
    s_barrier
    ds_read_b128 v[8:11], v3 offset:8192
    ds_read_b128 v[12:15], v3 offset:16384
    s_waitcnt lgkmcnt(1)
    buffer_store_dwordx4 v[8:11], v3, s[28:31], 0 offen sc1
    s_waitcnt lgkmcnt(0)
    buffer_store_dwordx4 v[12:15], v48, s[28:31], 0 offen sc1
    s_endpgm
L1_wprep:
    s_load_dwordx2 s[10:11], s[0:1], 40
    s_load_dwordx2 s[12:13], s[0:1], 48
    s_load_dwordx2 s[14:15], s[0:1], 56
    v_and_b32 v2, 31, v1
    v_lshrrev_b32 v3, 5, v1
    v_lshlrev_b32 v4, 4, v1
    s_waitcnt lgkmcnt(0)
    s_mov_b32 s16, s10
    s_mov_b32 s17, s11
    s_mov_b32 s18, 18560
    s_mov_b32 s19, 0x20000
    s_mov_b32 s20, s14
    s_mov_b32 s21, s15
    s_mov_b32 s22, 16384
    s_mov_b32 s23, 0x20000
    s_mov_b32 s24, s12
    s_mov_b32 s25, s13
    s_mov_b32 s26, 128
    s_mov_b32 s27, 0x20000
    s_add_u32 s28, s8, 4325376
    s_addc_u32 s29, s9, 0
    s_mov_b32 s30, 18944
    s_mov_b32 s31, 0x20000
    s_mov_b32 s32, 3216550459
    v_lshlrev_b32 v5, 1, v2
    v_lshl_add_u32 v6, v3, 10, v5
    v_lshl_add_u32 v7, v3, 9, v5
    v_lshlrev_b32 v8, 3, v3
    s_cmp_eq_u32 s3, 0
    s_cbranch_scc1 L1_w0
    s_cmp_eq_u32 s3, 1
    s_cbranch_scc1 L1_w1
    s_cmp_eq_u32 s3, 2
    s_cbranch_scc1 L1_w2
    s_cmp_eq_u32 s3, 3
    s_cbranch_scc1 L1_w3
    s_cmp_eq_u32 s3, 4
    s_cbranch_scc1 L1_w4
    s_cmp_eq_u32 s3, 5
    s_cbranch_scc1 L1_w5
    s_cmp_eq_u32 s3, 6
    s_cbranch_scc1 L1_w6
    s_cmp_eq_u32 s3, 7
    s_cbranch_scc1 L1_w7
    s_endpgm
L1_w0:
    v_add_u32 v10, 16512, v6
    buffer_load_ushort v16, v10, s[16:19], 0 offen offset:0
    buffer_load_ushort v17, v10, s[16:19], 0 offen offset:128
    buffer_load_ushort v18, v10, s[16:19], 0 offen offset:256
    buffer_load_ushort v19, v10, s[16:19], 0 offen offset:384
    buffer_load_ushort v20, v10, s[16:19], 0 offen offset:512
    buffer_load_ushort v21, v10, s[16:19], 0 offen offset:640
    buffer_load_ushort v22, v10, s[16:19], 0 offen offset:768
    buffer_load_ushort v23, v10, s[16:19], 0 offen offset:896
    v_add_u32 v10, 6144, v6
    buffer_load_ushort v24, v10, s[20:23], 0 offen offset:0
    buffer_load_ushort v25, v10, s[20:23], 0 offen offset:128
    buffer_load_ushort v26, v10, s[20:23], 0 offen offset:256
    buffer_load_ushort v27, v10, s[20:23], 0 offen offset:384
    buffer_load_ushort v28, v10, s[20:23], 0 offen offset:512
    buffer_load_ushort v29, v10, s[20:23], 0 offen offset:640
    buffer_load_ushort v30, v10, s[20:23], 0 offen offset:768
    buffer_load_ushort v31, v10, s[20:23], 0 offen offset:896
    v_add_u32 v10, 14336, v7
    buffer_load_ushort v32, v10, s[20:23], 0 offen offset:0
    buffer_load_ushort v33, v10, s[20:23], 0 offen offset:128
    buffer_load_ushort v34, v10, s[20:23], 0 offen offset:256
    buffer_load_ushort v35, v10, s[20:23], 0 offen offset:384
    buffer_load_ushort v36, v10, s[20:23], 0 offen offset:1024
    buffer_load_ushort v37, v10, s[20:23], 0 offen offset:1152
    buffer_load_ushort v38, v10, s[20:23], 0 offen offset:1280
    buffer_load_ushort v39, v10, s[20:23], 0 offen offset:1408
    v_lshlrev_b32 v11, 1, v1
    v_add_u32 v11, 16384, v11
    buffer_load_ushort v12, v11, s[16:19], 0 offen
    s_waitcnt vmcnt(0)
    v_lshlrev_b32 v16, 16, v16
    v_lshlrev_b32 v17, 16, v17
    v_lshlrev_b32 v18, 16, v18
    v_lshlrev_b32 v19, 16, v19
    v_lshlrev_b32 v20, 16, v20
    v_lshlrev_b32 v21, 16, v21
    v_lshlrev_b32 v22, 16, v22
    v_lshlrev_b32 v23, 16, v23
    v_mul_f32 v16, s32, v16
    v_mul_f32 v17, s32, v17
    v_mul_f32 v18, s32, v18
    v_mul_f32 v19, s32, v19
    v_mul_f32 v20, s32, v20
    v_mul_f32 v21, s32, v21
    v_mul_f32 v22, s32, v22
    v_mul_f32 v23, s32, v23
    v_cvt_pk_bf16_f32 v64, v16, v17
    v_cvt_pk_bf16_f32 v65, v18, v19
    v_cvt_pk_bf16_f32 v66, v20, v21
    v_cvt_pk_bf16_f32 v67, v22, v23
    v_add_u32 v10, 0, v4
    buffer_store_dwordx4 v[64:67], v10, s[28:31], 0 offen
    s_nop 1
    v_lshl_or_b32 v64, v25, 16, v24
    v_lshl_or_b32 v65, v27, 16, v26
    v_lshl_or_b32 v66, v29, 16, v28
    v_lshl_or_b32 v67, v31, 16, v30
    v_add_u32 v10, 8192, v4
    buffer_store_dwordx4 v[64:67], v10, s[28:31], 0 offen
    s_nop 1
    v_lshl_or_b32 v64, v33, 16, v32
    v_lshl_or_b32 v65, v35, 16, v34
    v_lshl_or_b32 v66, v37, 16, v36
    v_lshl_or_b32 v67, v39, 16, v38
    v_add_u32 v10, 16384, v4
    buffer_store_dwordx4 v[64:67], v10, s[28:31], 0 offen
    s_nop 1
    v_lshlrev_b32 v12, 16, v12
    v_mul_f32 v12, s32, v12
    v_cvt_pk_bf16_f32 v13, v12, v12
    v_and_b32 v14, 0xffff0000, v13
    v_sub_f32 v12, v12, v14
    v_cvt_pk_bf16_f32 v12, v12, v12
    v_and_b32 v12, 0xffff0000, v12
    v_and_b32 v13, 0xffff, v13
    v_or_b32 v13, v13, v12
    v_and_b32 v11, 31, v1
    v_lshlrev_b32 v11, 3, v11
    v_lshl_add_u32 v11, v3, 2, v11
    v_add_u32 v11, 18432, v11
    buffer_store_dword v13, v11, s[28:31], 0 offen
    s_endpgm
L1_w1:
    v_add_u32 v10, 16576, v6
    buffer_load_ushort v16, v10, s[16:19], 0 offen offset:0
    buffer_load_ushort v17, v10, s[16:19], 0 offen offset:128
    buffer_load_ushort v18, v10, s[16:19], 0 offen offset:256
    buffer_load_ushort v19, v10, s[16:19], 0 offen offset:384
    buffer_load_ushort v20, v10, s[16:19], 0 offen offset:512
    buffer_load_ushort v21, v10, s[16:19], 0 offen offset:640
    buffer_load_ushort v22, v10, s[16:19], 0 offen offset:768
    buffer_load_ushort v23, v10, s[16:19], 0 offen offset:896
    v_add_u32 v10, 6208, v6
    buffer_load_ushort v24, v10, s[20:23], 0 offen offset:0
    buffer_load_ushort v25, v10, s[20:23], 0 offen offset:128
    buffer_load_ushort v26, v10, s[20:23], 0 offen offset:256
    buffer_load_ushort v27, v10, s[20:23], 0 offen offset:384
    buffer_load_ushort v28, v10, s[20:23], 0 offen offset:512
    buffer_load_ushort v29, v10, s[20:23], 0 offen offset:640
    buffer_load_ushort v30, v10, s[20:23], 0 offen offset:768
    buffer_load_ushort v31, v10, s[20:23], 0 offen offset:896
    v_add_u32 v10, 14400, v7
    buffer_load_ushort v32, v10, s[20:23], 0 offen offset:0
    buffer_load_ushort v33, v10, s[20:23], 0 offen offset:128
    buffer_load_ushort v34, v10, s[20:23], 0 offen offset:256
    buffer_load_ushort v35, v10, s[20:23], 0 offen offset:384
    buffer_load_ushort v36, v10, s[20:23], 0 offen offset:1024
    buffer_load_ushort v37, v10, s[20:23], 0 offen offset:1152
    buffer_load_ushort v38, v10, s[20:23], 0 offen offset:1280
    buffer_load_ushort v39, v10, s[20:23], 0 offen offset:1408
    v_and_b32 v11, 3, v1
    v_bfe_u32 v12, v1, 2, 2
    v_lshl_add_u32 v11, v12, 3, v11
    v_bfe_u32 v12, v1, 4, 1
    v_lshl_add_u32 v11, v12, 5, v11
    v_lshl_add_u32 v11, v3, 2, v11
    v_lshlrev_b32 v11, 1, v11
    buffer_load_ushort v12, v11, s[24:27], 0 offen
    s_waitcnt vmcnt(0)
    v_lshlrev_b32 v16, 16, v16
    v_lshlrev_b32 v17, 16, v17
    v_lshlrev_b32 v18, 16, v18
    v_lshlrev_b32 v19, 16, v19
    v_lshlrev_b32 v20, 16, v20
    v_lshlrev_b32 v21, 16, v21
    v_lshlrev_b32 v22, 16, v22
    v_lshlrev_b32 v23, 16, v23
    v_mul_f32 v16, s32, v16
    v_mul_f32 v17, s32, v17
    v_mul_f32 v18, s32, v18
    v_mul_f32 v19, s32, v19
    v_mul_f32 v20, s32, v20
    v_mul_f32 v21, s32, v21
    v_mul_f32 v22, s32, v22
    v_mul_f32 v23, s32, v23
    v_cvt_pk_bf16_f32 v64, v16, v17
    v_cvt_pk_bf16_f32 v65, v18, v19
    v_cvt_pk_bf16_f32 v66, v20, v21
    v_cvt_pk_bf16_f32 v67, v22, v23
    v_add_u32 v10, 1024, v4
    buffer_store_dwordx4 v[64:67], v10, s[28:31], 0 offen
    s_nop 1
    v_lshl_or_b32 v64, v25, 16, v24
    v_lshl_or_b32 v65, v27, 16, v26
    v_lshl_or_b32 v66, v29, 16, v28
    v_lshl_or_b32 v67, v31, 16, v30
    v_add_u32 v10, 9216, v4
    buffer_store_dwordx4 v[64:67], v10, s[28:31], 0 offen
    s_nop 1
    v_lshl_or_b32 v64, v33, 16, v32
    v_lshl_or_b32 v65, v35, 16, v34
    v_lshl_or_b32 v66, v37, 16, v36
    v_lshl_or_b32 v67, v39, 16, v38
    v_add_u32 v10, 17408, v4
    buffer_store_dwordx4 v[64:67], v10, s[28:31], 0 offen
    s_nop 1
    v_lshlrev_b32 v12, 16, v12
    v_lshlrev_b32 v11, 2, v1
    v_add_u32 v11, 18688, v11
    buffer_store_dword v12, v11, s[28:31], 0 offen
    s_endpgm
L1_w2:
    v_add_u32 v10, 0, v6
    buffer_load_ushort v16, v10, s[20:23], 0 offen offset:0
    buffer_load_ushort v17, v10, s[20:23], 0 offen offset:128
    buffer_load_ushort v18, v10, s[20:23], 0 offen offset:256
    buffer_load_ushort v19, v10, s[20:23], 0 offen offset:384
    buffer_load_ushort v20, v10, s[20:23], 0 offen offset:512
    buffer_load_ushort v21, v10, s[20:23], 0 offen offset:640
    buffer_load_ushort v22, v10, s[20:23], 0 offen offset:768
    buffer_load_ushort v23, v10, s[20:23], 0 offen offset:896
    v_add_u32 v10, 8192, v7
    buffer_load_ushort v24, v10, s[20:23], 0 offen offset:0
    buffer_load_ushort v25, v10, s[20:23], 0 offen offset:128
    buffer_load_ushort v26, v10, s[20:23], 0 offen offset:256
    buffer_load_ushort v27, v10, s[20:23], 0 offen offset:384
    buffer_load_ushort v28, v10, s[20:23], 0 offen offset:1024
    buffer_load_ushort v29, v10, s[20:23], 0 offen offset:1152
    buffer_load_ushort v30, v10, s[20:23], 0 offen offset:1280
    buffer_load_ushort v31, v10, s[20:23], 0 offen offset:1408
    s_waitcnt vmcnt(0)
    v_lshl_or_b32 v64, v17, 16, v16
    v_lshl_or_b32 v65, v19, 16, v18
    v_lshl_or_b32 v66, v21, 16, v20
    v_lshl_or_b32 v67, v23, 16, v22
    v_add_u32 v10, 2048, v4
    buffer_store_dwordx4 v[64:67], v10, s[28:31], 0 offen
    s_nop 1
    v_lshl_or_b32 v64, v25, 16, v24
    v_lshl_or_b32 v65, v27, 16, v26
    v_lshl_or_b32 v66, v29, 16, v28
    v_lshl_or_b32 v67, v31, 16, v30
    v_add_u32 v10, 10240, v4
    buffer_store_dwordx4 v[64:67], v10, s[28:31], 0 offen
    s_nop 1
    s_endpgm
L1_w3:
    v_add_u32 v10, 64, v6
    buffer_load_ushort v16, v10, s[20:23], 0 offen offset:0
    buffer_load_ushort v17, v10, s[20:23], 0 offen offset:128
    buffer_load_ushort v18, v10, s[20:23], 0 offen offset:256
    buffer_load_ushort v19, v10, s[20:23], 0 offen offset:384
    buffer_load_ushort v20, v10, s[20:23], 0 offen offset:512
    buffer_load_ushort v21, v10, s[20:23], 0 offen offset:640
    buffer_load_ushort v22, v10, s[20:23], 0 offen offset:768
    buffer_load_ushort v23, v10, s[20:23], 0 offen offset:896
    v_add_u32 v10, 8256, v7
    buffer_load_ushort v24, v10, s[20:23], 0 offen offset:0
    buffer_load_ushort v25, v10, s[20:23], 0 offen offset:128
    buffer_load_ushort v26, v10, s[20:23], 0 offen offset:256
    buffer_load_ushort v27, v10, s[20:23], 0 offen offset:384
    buffer_load_ushort v28, v10, s[20:23], 0 offen offset:1024
    buffer_load_ushort v29, v10, s[20:23], 0 offen offset:1152
    buffer_load_ushort v30, v10, s[20:23], 0 offen offset:1280
    buffer_load_ushort v31, v10, s[20:23], 0 offen offset:1408
    s_waitcnt vmcnt(0)
    v_lshl_or_b32 v64, v17, 16, v16
    v_lshl_or_b32 v65, v19, 16, v18
    v_lshl_or_b32 v66, v21, 16, v20
    v_lshl_or_b32 v67, v23, 16, v22
    v_add_u32 v10, 3072, v4
    buffer_store_dwordx4 v[64:67], v10, s[28:31], 0 offen
    s_nop 1
    v_lshl_or_b32 v64, v25, 16, v24
    v_lshl_or_b32 v65, v27, 16, v26
    v_lshl_or_b32 v66, v29, 16, v28
    v_lshl_or_b32 v67, v31, 16, v30
    v_add_u32 v10, 11264, v4
    buffer_store_dwordx4 v[64:67], v10, s[28:31], 0 offen
    s_nop 1
    s_endpgm
L1_w4:
    v_add_u32 v10, 2048, v6
    buffer_load_ushort v16, v10, s[20:23], 0 offen offset:0
    buffer_load_ushort v17, v10, s[20:23], 0 offen offset:128
    buffer_load_ushort v18, v10, s[20:23], 0 offen offset:256
    buffer_load_ushort v19, v10, s[20:23], 0 offen offset:384
    buffer_load_ushort v20, v10, s[20:23], 0 offen offset:512
    buffer_load_ushort v21, v10, s[20:23], 0 offen offset:640
    buffer_load_ushort v22, v10, s[20:23], 0 offen offset:768
    buffer_load_ushort v23, v10, s[20:23], 0 offen offset:896
    v_add_u32 v10, 10240, v7
    buffer_load_ushort v24, v10, s[20:23], 0 offen offset:0
    buffer_load_ushort v25, v10, s[20:23], 0 offen offset:128
    buffer_load_ushort v26, v10, s[20:23], 0 offen offset:256
    buffer_load_ushort v27, v10, s[20:23], 0 offen offset:384
    buffer_load_ushort v28, v10, s[20:23], 0 offen offset:1024
    buffer_load_ushort v29, v10, s[20:23], 0 offen offset:1152
    buffer_load_ushort v30, v10, s[20:23], 0 offen offset:1280
    buffer_load_ushort v31, v10, s[20:23], 0 offen offset:1408
    s_waitcnt vmcnt(0)
    v_lshl_or_b32 v64, v17, 16, v16
    v_lshl_or_b32 v65, v19, 16, v18
    v_lshl_or_b32 v66, v21, 16, v20
    v_lshl_or_b32 v67, v23, 16, v22
    v_add_u32 v10, 4096, v4
    buffer_store_dwordx4 v[64:67], v10, s[28:31], 0 offen
    s_nop 1
    v_lshl_or_b32 v64, v25, 16, v24
    v_lshl_or_b32 v65, v27, 16, v26
    v_lshl_or_b32 v66, v29, 16, v28
    v_lshl_or_b32 v67, v31, 16, v30
    v_add_u32 v10, 12288, v4
    buffer_store_dwordx4 v[64:67], v10, s[28:31], 0 offen
    s_nop 1
    s_endpgm
L1_w5:
    v_add_u32 v10, 2112, v6
    buffer_load_ushort v16, v10, s[20:23], 0 offen offset:0
    buffer_load_ushort v17, v10, s[20:23], 0 offen offset:128
    buffer_load_ushort v18, v10, s[20:23], 0 offen offset:256
    buffer_load_ushort v19, v10, s[20:23], 0 offen offset:384
    buffer_load_ushort v20, v10, s[20:23], 0 offen offset:512
    buffer_load_ushort v21, v10, s[20:23], 0 offen offset:640
    buffer_load_ushort v22, v10, s[20:23], 0 offen offset:768
    buffer_load_ushort v23, v10, s[20:23], 0 offen offset:896
    v_add_u32 v10, 10304, v7
    buffer_load_ushort v24, v10, s[20:23], 0 offen offset:0
    buffer_load_ushort v25, v10, s[20:23], 0 offen offset:128
    buffer_load_ushort v26, v10, s[20:23], 0 offen offset:256
    buffer_load_ushort v27, v10, s[20:23], 0 offen offset:384
    buffer_load_ushort v28, v10, s[20:23], 0 offen offset:1024
    buffer_load_ushort v29, v10, s[20:23], 0 offen offset:1152
    buffer_load_ushort v30, v10, s[20:23], 0 offen offset:1280
    buffer_load_ushort v31, v10, s[20:23], 0 offen offset:1408
    s_waitcnt vmcnt(0)
    v_lshl_or_b32 v64, v17, 16, v16
    v_lshl_or_b32 v65, v19, 16, v18
    v_lshl_or_b32 v66, v21, 16, v20
    v_lshl_or_b32 v67, v23, 16, v22
    v_add_u32 v10, 5120, v4
    buffer_store_dwordx4 v[64:67], v10, s[28:31], 0 offen
    s_nop 1
    v_lshl_or_b32 v64, v25, 16, v24
    v_lshl_or_b32 v65, v27, 16, v26
    v_lshl_or_b32 v66, v29, 16, v28
    v_lshl_or_b32 v67, v31, 16, v30
    v_add_u32 v10, 13312, v4
    buffer_store_dwordx4 v[64:67], v10, s[28:31], 0 offen
    s_nop 1
    s_endpgm
L1_w6:
    v_add_u32 v10, 4096, v6
    buffer_load_ushort v16, v10, s[20:23], 0 offen offset:0
    buffer_load_ushort v17, v10, s[20:23], 0 offen offset:128
    buffer_load_ushort v18, v10, s[20:23], 0 offen offset:256
    buffer_load_ushort v19, v10, s[20:23], 0 offen offset:384
    buffer_load_ushort v20, v10, s[20:23], 0 offen offset:512
    buffer_load_ushort v21, v10, s[20:23], 0 offen offset:640
    buffer_load_ushort v22, v10, s[20:23], 0 offen offset:768
    buffer_load_ushort v23, v10, s[20:23], 0 offen offset:896
    v_add_u32 v10, 12288, v7
    buffer_load_ushort v24, v10, s[20:23], 0 offen offset:0
    buffer_load_ushort v25, v10, s[20:23], 0 offen offset:128
    buffer_load_ushort v26, v10, s[20:23], 0 offen offset:256
    buffer_load_ushort v27, v10, s[20:23], 0 offen offset:384
    buffer_load_ushort v28, v10, s[20:23], 0 offen offset:1024
    buffer_load_ushort v29, v10, s[20:23], 0 offen offset:1152
    buffer_load_ushort v30, v10, s[20:23], 0 offen offset:1280
    buffer_load_ushort v31, v10, s[20:23], 0 offen offset:1408
    s_waitcnt vmcnt(0)
    v_lshl_or_b32 v64, v17, 16, v16
    v_lshl_or_b32 v65, v19, 16, v18
    v_lshl_or_b32 v66, v21, 16, v20
    v_lshl_or_b32 v67, v23, 16, v22
    v_add_u32 v10, 6144, v4
    buffer_store_dwordx4 v[64:67], v10, s[28:31], 0 offen
    s_nop 1
    v_lshl_or_b32 v64, v25, 16, v24
    v_lshl_or_b32 v65, v27, 16, v26
    v_lshl_or_b32 v66, v29, 16, v28
    v_lshl_or_b32 v67, v31, 16, v30
    v_add_u32 v10, 14336, v4
    buffer_store_dwordx4 v[64:67], v10, s[28:31], 0 offen
    s_nop 1
    s_endpgm
L1_w7:
    v_add_u32 v10, 4160, v6
    buffer_load_ushort v16, v10, s[20:23], 0 offen offset:0
    buffer_load_ushort v17, v10, s[20:23], 0 offen offset:128
    buffer_load_ushort v18, v10, s[20:23], 0 offen offset:256
    buffer_load_ushort v19, v10, s[20:23], 0 offen offset:384
    buffer_load_ushort v20, v10, s[20:23], 0 offen offset:512
    buffer_load_ushort v21, v10, s[20:23], 0 offen offset:640
    buffer_load_ushort v22, v10, s[20:23], 0 offen offset:768
    buffer_load_ushort v23, v10, s[20:23], 0 offen offset:896
    v_add_u32 v10, 12352, v7
    buffer_load_ushort v24, v10, s[20:23], 0 offen offset:0
    buffer_load_ushort v25, v10, s[20:23], 0 offen offset:128
    buffer_load_ushort v26, v10, s[20:23], 0 offen offset:256
    buffer_load_ushort v27, v10, s[20:23], 0 offen offset:384
    buffer_load_ushort v28, v10, s[20:23], 0 offen offset:1024
    buffer_load_ushort v29, v10, s[20:23], 0 offen offset:1152
    buffer_load_ushort v30, v10, s[20:23], 0 offen offset:1280
    buffer_load_ushort v31, v10, s[20:23], 0 offen offset:1408
    s_waitcnt vmcnt(0)
    v_lshl_or_b32 v64, v17, 16, v16
    v_lshl_or_b32 v65, v19, 16, v18
    v_lshl_or_b32 v66, v21, 16, v20
    v_lshl_or_b32 v67, v23, 16, v22
    v_add_u32 v10, 7168, v4
    buffer_store_dwordx4 v[64:67], v10, s[28:31], 0 offen
    s_nop 1
    v_lshl_or_b32 v64, v25, 16, v24
    v_lshl_or_b32 v65, v27, 16, v26
    v_lshl_or_b32 v66, v29, 16, v28
    v_lshl_or_b32 v67, v31, 16, v30
    v_add_u32 v10, 15360, v4
    buffer_store_dwordx4 v[64:67], v10, s[28:31], 0 offen
    s_nop 1
    s_endpgm
L1_tables:
    s_load_dwordx2 s[10:11], s[0:1], 0
    s_load_dwordx2 s[12:13], s[0:1], 40
    s_sub_u32 s14, s2, 251
    s_lshl_b32 s14, s14, 7
    s_lshr_b32 s33, s3, 1
    s_lshl_b32 s33, s33, 5
    s_and_b32 s15, s3, 1
    v_and_b32 v2, 31, v1
    v_lshrrev_b32 v3, 5, v1
    v_lshrrev_b32 v8, 3, v1
    v_and_b32 v9, 7, v1
    v_lshrrev_b32 v10, 4, v1
    s_waitcnt lgkmcnt(0)
    s_mov_b32 s16, s10
    s_or_b32 s17, s11, 0x800000
    s_mov_b32 s18, 12500
    s_mov_b32 s19, 0x20000
    s_mov_b32 s20, s12
    s_mov_b32 s21, s13
    s_mov_b32 s22, 16384
    s_mov_b32 s23, 0x20000
    s_mul_i32 s34, s15, 2097152
    s_add_u32 s34, s34, 5242880
    s_add_u32 s24, s8, s34
    s_addc_u32 s25, s9, 0
    s_or_b32 s25, s25, 0x800000
    s_mov_b32 s26, 12500
    s_mov_b32 s27, 0x20000
    s_lshl_b32 s34, s3, 1
    s_add_u32 s34, s34, 0
    s_lshl_b32 s35, s34, 3
    s_add_u32 s35, s35, s14
    v_add_u32 v4, s35, v8
    v_add_u32 v5, 0, v10
    v_xor_b32 v5, v5, v9
    v_lshlrev_b32 v5, 4, v5
    s_lshl_b32 s34, s34, 10
    s_add_u32 m0, s34, 16384
    s_nop 0
    buffer_load_dwordx4 v[4:5], s[16:19], 0 idxen offen lds
    s_lshl_b32 s34, s3, 1
    s_add_u32 s34, s34, 1
    s_lshl_b32 s35, s34, 3
    s_add_u32 s35, s35, s14
    v_add_u32 v4, s35, v8
    v_add_u32 v5, 4, v10
    v_xor_b32 v5, v5, v9
    v_lshlrev_b32 v5, 4, v5
    s_lshl_b32 s34, s34, 10
    s_add_u32 m0, s34, 16384
    s_nop 0
    buffer_load_dwordx4 v[4:5], s[16:19], 0 idxen offen lds
    v_lshlrev_b32 v6, 4, v1
    s_lshl_b32 s34, s3, 10
    v_add_u32 v6, s34, v6
    s_mov_b32 m0, s34
    v_add_u32 v7, 8192, v6
    buffer_load_dwordx4 v6, s[20:23], 0 offen lds
    s_add_u32 m0, s34, 8192
    s_nop 0
    buffer_load_dwordx4 v7, s[20:23], 0 offen lds
    v_and_b32 v8, 15, v1
    v_lshrrev_b32 v9, 2, v8
    v_lshl_add_u32 v9, v3, 3, v9
    v_lshlrev_b32 v9, 7, v9
    v_bfe_u32 v10, v1, 4, 1
    v_lshl_add_u32 v9, v10, 5, v9
    v_and_b32 v10, 3, v1
    v_lshl_add_u32 v9, v10, 3, v9
    s_lshl_b32 s34, s15, 13
    v_add_u32 v9, s34, v9
    v_add_u32 v10, s33, v2
    v_lshlrev_b32 v10, 7, v10
    v_add_u32 v10, 16384, v10
    v_bfe_u32 v11, v2, 1, 3
    s_mov_b32 s35, 3216550459
    s_waitcnt vmcnt(0)
    s_barrier
    v_add_u32 v12, 0, v3
    v_xor_b32 v12, v12, v11
    v_lshl_add_u32 v12, v12, 4, v10
    ds_read_b128 v[16:19], v12
    v_add_u32 v12, 2, v3
    v_xor_b32 v12, v12, v11
    v_lshl_add_u32 v12, v12, 4, v10
    ds_read_b128 v[20:23], v12
    v_add_u32 v12, 4, v3
    v_xor_b32 v12, v12, v11
    v_lshl_add_u32 v12, v12, 4, v10
    ds_read_b128 v[24:27], v12
    v_add_u32 v12, 6, v3
    v_xor_b32 v12, v12, v11
    v_lshl_add_u32 v12, v12, 4, v10
    ds_read_b128 v[28:31], v12
    ds_read_b64_tr_b16 v[32:33], v9 offset:0
    ds_read_b64_tr_b16 v[34:35], v9 offset:512
    ds_read_b64_tr_b16 v[36:37], v9 offset:64
    ds_read_b64_tr_b16 v[38:39], v9 offset:576
    ds_read_b64_tr_b16 v[40:41], v9 offset:2048
    ds_read_b64_tr_b16 v[42:43], v9 offset:2560
    ds_read_b64_tr_b16 v[44:45], v9 offset:2112
    ds_read_b64_tr_b16 v[46:47], v9 offset:2624
    s_waitcnt lgkmcnt(0)
    ds_read_b64_tr_b16 v[48:49], v9 offset:4096
    ds_read_b64_tr_b16 v[50:51], v9 offset:4608
    ds_read_b64_tr_b16 v[52:53], v9 offset:4160
    ds_read_b64_tr_b16 v[54:55], v9 offset:4672
    ds_read_b64_tr_b16 v[56:57], v9 offset:6144
    ds_read_b64_tr_b16 v[58:59], v9 offset:6656
    ds_read_b64_tr_b16 v[60:61], v9 offset:6208
    ds_read_b64_tr_b16 v[62:63], v9 offset:6720
    s_waitcnt lgkmcnt(0)
    s_barrier
    v_mfma_f32_32x32x16_bf16 v[64:79], v[32:35], v[16:19], 0
    v_mfma_f32_32x32x16_bf16 v[64:79], v[40:43], v[20:23], v[64:79]
    v_mfma_f32_32x32x16_bf16 v[64:79], v[48:51], v[24:27], v[64:79]
    v_mfma_f32_32x32x16_bf16 v[64:79], v[56:59], v[28:31], v[64:79]
    v_mfma_f32_32x32x16_bf16 v[80:95], v[36:39], v[16:19], 0
    v_mfma_f32_32x32x16_bf16 v[80:95], v[44:47], v[20:23], v[80:95]
    v_mfma_f32_32x32x16_bf16 v[80:95], v[52:55], v[24:27], v[80:95]
    v_mfma_f32_32x32x16_bf16 v[80:95], v[60:63], v[28:31], v[80:95]
    s_lshl_b32 s34, s3, 12
    v_lshlrev_b32 v4, 7, v2
    v_add_u32 v4, s34, v4
    v_and_b32 v5, 7, v2
    v_lshlrev_b32 v5, 4, v5
    s_nop 2
    v_mul_f32 v64, s35, v64
    v_mul_f32 v65, s35, v65
    v_mul_f32 v66, s35, v66
    v_mul_f32 v67, s35, v67
    v_mul_f32 v68, s35, v68
    v_mul_f32 v69, s35, v69
    v_mul_f32 v70, s35, v70
    v_mul_f32 v71, s35, v71
    v_mul_f32 v72, s35, v72
    v_mul_f32 v73, s35, v73
    v_mul_f32 v74, s35, v74
    v_mul_f32 v75, s35, v75
    v_mul_f32 v76, s35, v76
    v_mul_f32 v77, s35, v77
    v_mul_f32 v78, s35, v78
    v_mul_f32 v79, s35, v79
    v_mul_f32 v80, s35, v80
    v_mul_f32 v81, s35, v81
    v_mul_f32 v82, s35, v82
    v_mul_f32 v83, s35, v83
    v_mul_f32 v84, s35, v84
    v_mul_f32 v85, s35, v85
    v_mul_f32 v86, s35, v86
    v_mul_f32 v87, s35, v87
    v_mul_f32 v88, s35, v88
    v_mul_f32 v89, s35, v89
    v_mul_f32 v90, s35, v90
    v_mul_f32 v91, s35, v91
    v_mul_f32 v92, s35, v92
    v_mul_f32 v93, s35, v93
    v_mul_f32 v94, s35, v94
    v_mul_f32 v95, s35, v95
    s_cmp_eq_u32 s15, 0
    s_cbranch_scc1 L1_tabA
    v_lshl_add_u32 v4, v3, 3, v4
    v_cvt_pk_bf16_f32 v32, v64, v65
    v_cvt_pk_bf16_f32 v33, v66, v67
    v_cvt_pk_bf16_f32 v34, v68, v69
    v_cvt_pk_bf16_f32 v35, v70, v71
    v_cvt_pk_bf16_f32 v36, v72, v73
    v_cvt_pk_bf16_f32 v37, v74, v75
    v_cvt_pk_bf16_f32 v38, v76, v77
    v_cvt_pk_bf16_f32 v39, v78, v79
    v_xor_b32 v6, 0, v5
    v_add_u32 v6, v6, v4
    ds_write_b64 v6, v[32:33]
    v_xor_b32 v6, 16, v5
    v_add_u32 v6, v6, v4
    ds_write_b64 v6, v[34:35]
    v_xor_b32 v6, 32, v5
    v_add_u32 v6, v6, v4
    ds_write_b64 v6, v[36:37]
    v_xor_b32 v6, 48, v5
    v_add_u32 v6, v6, v4
    ds_write_b64 v6, v[38:39]
    v_cvt_pk_bf16_f32 v40, v80, v81
    v_cvt_pk_bf16_f32 v41, v82, v83
    v_cvt_pk_bf16_f32 v42, v84, v85
    v_cvt_pk_bf16_f32 v43, v86, v87
    v_cvt_pk_bf16_f32 v44, v88, v89
    v_cvt_pk_bf16_f32 v45, v90, v91
    v_cvt_pk_bf16_f32 v46, v92, v93
    v_cvt_pk_bf16_f32 v47, v94, v95
    v_xor_b32 v6, 64, v5
    v_add_u32 v6, v6, v4
    ds_write_b64 v6, v[40:41]
    v_xor_b32 v6, 80, v5
    v_add_u32 v6, v6, v4
    ds_write_b64 v6, v[42:43]
    v_xor_b32 v6, 96, v5
    v_add_u32 v6, v6, v4
    ds_write_b64 v6, v[44:45]
    v_xor_b32 v6, 112, v5
    v_add_u32 v6, v6, v4
    ds_write_b64 v6, v[46:47]
    s_branch L1_tabS
L1_tabA:
    v_cvt_pk_bf16_f32 v32, v64, v80
    v_cvt_pk_bf16_f32 v33, v65, v81
    v_cvt_pk_bf16_f32 v34, v66, v82
    v_cvt_pk_bf16_f32 v35, v67, v83
    v_cvt_pk_bf16_f32 v36, v68, v84
    v_cvt_pk_bf16_f32 v37, v69, v85
    v_cvt_pk_bf16_f32 v38, v70, v86
    v_cvt_pk_bf16_f32 v39, v71, v87
    v_cvt_pk_bf16_f32 v40, v72, v88
    v_cvt_pk_bf16_f32 v41, v73, v89
    v_cvt_pk_bf16_f32 v42, v74, v90
    v_cvt_pk_bf16_f32 v43, v75, v91
    v_cvt_pk_bf16_f32 v44, v76, v92
    v_cvt_pk_bf16_f32 v45, v77, v93
    v_cvt_pk_bf16_f32 v46, v78, v94
    v_cvt_pk_bf16_f32 v47, v79, v95
    v_lshlrev_b32 v7, 4, v3
    v_add_u32 v6, 0, v7
    v_xor_b32 v6, v6, v5
    v_add_u32 v6, v6, v4
    ds_write_b128 v6, v[32:35]
    v_add_u32 v6, 32, v7
    v_xor_b32 v6, v6, v5
    v_add_u32 v6, v6, v4
    ds_write_b128 v6, v[36:39]
    v_add_u32 v6, 64, v7
    v_xor_b32 v6, v6, v5
    v_add_u32 v6, v6, v4
    ds_write_b128 v6, v[40:43]
    v_add_u32 v6, 96, v7
    v_xor_b32 v6, v6, v5
    v_add_u32 v6, v6, v4
    ds_write_b128 v6, v[44:47]
L1_tabS:
    v_lshlrev_b32 v6, 4, v1
    v_add_u32 v6, s34, v6
    v_lshrrev_b32 v8, 3, v1
    v_and_b32 v9, 7, v1
    v_xor_b32 v9, v9, v8
    v_lshlrev_b32 v13, 4, v9
    s_add_u32 s14, s14, s33
    v_add_u32 v8, s14, v8
    s_waitcnt lgkmcnt(0)
    ds_read_b128 v[48:51], v6 offset:0
    ds_read_b128 v[52:55], v6 offset:1024
    ds_read_b128 v[56:59], v6 offset:2048
    ds_read_b128 v[60:63], v6 offset:3072
    v_add_u32 v12, 0, v8
    s_waitcnt lgkmcnt(3)
    buffer_store_dwordx4 v[48:51], v[12:13], s[24:27], 0 idxen offen sc1
    s_nop 1
    v_add_u32 v12, 8, v8
    s_waitcnt lgkmcnt(2)
    buffer_store_dwordx4 v[52:55], v[12:13], s[24:27], 0 idxen offen sc1
    s_nop 1
    v_add_u32 v12, 16, v8
    s_waitcnt lgkmcnt(1)
    buffer_store_dwordx4 v[56:59], v[12:13], s[24:27], 0 idxen offen sc1
    s_nop 1
    v_add_u32 v12, 24, v8
    s_waitcnt lgkmcnt(0)
    buffer_store_dwordx4 v[60:63], v[12:13], s[24:27], 0 idxen offen sc1
    s_endpgm
L1_end:
    s_endpgm
.globl egnn_main_kernel
.p2align 8
.type egnn_main_kernel,@function
egnn_main_kernel:
    s_cmp_ge_u32 s2, 256
    s_cbranch_scc1 L2_end
    s_and_b32 s4, s2, 7
    s_lshl_b32 s4, s4, 5
    s_lshr_b32 s2, s2, 3
    s_or_b32 s2, s2, s4
    s_load_dwordx2 s[44:45], s[0:1], 80
    s_load_dwordx4 s[36:39], s[0:1], 0
    s_load_dwordx2 s[40:41], s[0:1], 16
    s_load_dwordx2 s[42:43], s[0:1], 64
    v_and_b32 v1, 63, v0
    v_lshrrev_b32 v2, 6, v0
    v_lshrrev_b32 v3, 1, v0
    v_readfirstlane_b32 s3, v2
    v_and_b32 v9, 1, v0
    s_lshl_b32 s54, s2, 4
    s_mov_b32 s55, 4224
    v_mov_b32 v96, s54
    v_mad_u32_u24 v96, v3, s55, v96
    s_mov_b32 s14, 1056000
    s_mov_b32 s15, 0x20000
    s_waitcnt lgkmcnt(0)
    s_add_u32 s12, s44, 0
    s_addc_u32 s13, s45, 0
    buffer_load_dwordx4 v[4:7], v96, s[12:15], 0 offen
    buffer_load_ushort v8, v96, s[12:15], 0 offen offset:16
    s_mov_b32 s20, s38
    s_mov_b32 s21, s39
    s_mov_b32 s22, 75000
    s_mov_b32 s23, 0x20000
    s_add_u32 s24, s44, 4325376
    s_addc_u32 s25, s45, 0
    s_mov_b32 s26, 18944
    s_mov_b32 s27, 0x20000
    s_mov_b32 s46, 0
    s_mov_b32 s47, 250
    s_mov_b32 s63, 2
    v_lshlrev_b32 v96, 4, v1
    s_lshl_b32 s58, s3, 10
    v_add_u32 v96, s58, v96
    s_add_u32 m0, s58, 66816
    v_add_u32 v97, 0, v96
    buffer_load_dwordx4 v97, s[20:23], 0 offen lds
    s_mov_b32 s4, s36
    s_or_b32 s5, s37, 0x800000
    s_mov_b32 s6, 12500
    s_mov_b32 s7, 0x20000
    s_mov_b32 s8, s40
    s_mov_b32 s9, s41
    s_mov_b32 s10, 25600000
    s_mov_b32 s11, 0x20000
    s_add_u32 s16, s44, 1114112
    s_addc_u32 s17, s45, 0
    s_mov_b32 s18, 3200000
    s_mov_b32 s19, 0x20000
    s_add_u32 m0, s58, 75008
    v_add_u32 v97, 8192, v96
    buffer_load_dwordx4 v97, s[20:23], 0 offen lds
    s_mov_b32 s28, s42
    s_or_b32 s29, s43, 0x800000
    s_mov_b32 s30, 12500
    s_mov_b32 s31, 0x20000
    s_add_u32 s32, s42, 1600000
    s_addc_u32 s33, s43, 0
    s_mov_b32 s34, 75000
    s_mov_b32 s35, 0x20000
    s_add_u32 s36, s44, 7340032
    s_addc_u32 s37, s45, 0
    s_or_b32 s37, s37, 0x800000
    s_mov_b32 s38, 12500
    s_mov_b32 s39, 0x20000
    s_add_u32 m0, s58, 83200
    v_add_u32 v97, 16384, v96
    buffer_load_dwordx4 v97, s[20:23], 0 offen lds
    s_add_u32 s40, s44, 5242880
    s_addc_u32 s41, s45, 0
    s_or_b32 s41, s41, 0x800000
    s_mov_b32 s42, 12500
    s_mov_b32 s43, 0x20000
    s_mul_i32 s52, s3, 10240
    s_add_u32 s52, s52, 66816
    s_mov_b32 s89, 0xffffffe0
    s_mov_b32 s100, 0x01000100
    v_lshrrev_b32 v98, 5, v1
    v_and_b32 v101, 1, v1
    v_xor_b32 v101, v101, v98
    v_lshlrev_b32 v238, 4, v101
    s_add_u32 m0, s58, 91392
    v_add_u32 v97, 24576, v96
    buffer_load_dwordx4 v97, s[20:23], 0 offen lds
    v_and_b32 v101, 7, v1
    v_lshrrev_b32 v102, 4, v1
    v_xor_b32 v103, v101, v102
    v_lshlrev_b32 v241, 4, v103
    v_lshlrev_b32 v245, 4, v103
    v_add_u32 v102, 4, v102
    v_xor_b32 v103, v101, v102
    v_lshlrev_b32 v243, 4, v103
    v_lshlrev_b32 v247, 4, v103
    s_add_u32 m0, s58, 99584
    v_add_u32 v97, 32768, v96
    buffer_load_dwordx4 v97, s[20:23], 0 offen lds
    v_mov_b32 v212, 0
    v_mov_b32 v213, 0
    v_mov_b32 v214, 0
    v_mov_b32 v215, 0
    s_nop 1
    v_mfma_f32_32x32x16_bf16 v[64:79], v[212:215], v[212:215], 0
    v_mfma_f32_32x32x16_bf16 v[80:95], v[212:215], v[212:215], 0
    s_cmp_eq_u32 s3, 2
    s_cselect_b32 s54, 18432, s58
    s_cselect_b32 s55, 2048, s58
    v_lshlrev_b32 v97, 4, v1
    v_add_u32 v97, s54, v97
    s_add_u32 m0, s55, 158208
    s_cmp_gt_u32 s3, 2
    s_cbranch_scc1 L2_nowst
    v_cmp_gt_u32 vcc, 32, v1
    s_cmp_eq_u32 s3, 2
    s_cselect_b64 exec, vcc, -1
    buffer_load_dwordx4 v97, s[24:27], 0 offen lds
    s_mov_b64 exec, -1
L2_nowst:
    s_waitcnt vmcnt(5)
    s_branch L2_counts
L2_batch:
    s_barrier
    v_lshlrev_b32 v96, 4, v1
    s_lshl_b32 s58, s3, 10
    v_add_u32 v96, s58, v96
    s_add_u32 m0, s58, 66816
    v_add_u32 v97, 0, v96
    buffer_load_dwordx4 v97, s[20:23], 0 offen lds
    s_add_u32 m0, s58, 75008
    v_add_u32 v97, 8192, v96
    buffer_load_dwordx4 v97, s[20:23], 0 offen lds
    s_add_u32 m0, s58, 83200
    v_add_u32 v97, 16384, v96
    buffer_load_dwordx4 v97, s[20:23], 0 offen lds
    s_add_u32 m0, s58, 91392
    v_add_u32 v97, 24576, v96
    buffer_load_dwordx4 v97, s[20:23], 0 offen lds
    s_add_u32 m0, s58, 99584
    v_add_u32 v97, 32768, v96
    buffer_load_dwordx4 v97, s[20:23], 0 offen lds
L2_counts:
    v_alignbit_b32 v100, v5, v4, 16
    v_alignbit_b32 v101, v6, v5, 16
    v_alignbit_b32 v102, v7, v6, 16
    v_alignbit_b32 v103, v8, v7, 16
    v_and_b32 v105, 0xffff, v4
    v_sub_u32 v104, v8, v105
    s_sub_u32 s54, s47, s46
    v_subrev_u32 v106, s46, v3
    v_cmp_gt_u32 vcc, s54, v106
    s_mov_b32 s55, 12800
    v_lshlrev_b32 v107, 2, v105
    v_lshl_add_u32 v107, v9, 4, v107
    v_cndmask_b32 v104, 0, v104, vcc
    v_lshlrev_b32 v109, 2, v9
    v_sub_u32 v109, v104, v109
    v_max_i32 v109, 0, v109
    v_mad_u32_u24 v107, v3, s55, v107
    v_cmp_lt_u32 s[90:91], 0, v109
    v_cmp_lt_u32 s[92:93], 8, v109
    v_cmp_lt_u32 s[94:95], 16, v109
    v_cmp_lt_u32 s[96:97], 24, v109
    s_mov_b64 exec, s[90:91]
    s_cbranch_execz L2_e0
    buffer_load_dwordx4 v[192:195], v107, s[16:19], 0 offen offset:0
L2_e0:
    s_mov_b64 exec, s[92:93]
    s_cbranch_execz L2_e1
    buffer_load_dwordx4 v[196:199], v107, s[16:19], 0 offen offset:32
L2_e1:
    s_mov_b64 exec, s[94:95]
    s_cbranch_execz L2_e2
    buffer_load_dwordx4 v[200:203], v107, s[16:19], 0 offen offset:64
L2_e2:
    s_mov_b64 exec, s[96:97]
    s_cbranch_execz L2_e3
    buffer_load_dwordx4 v[204:207], v107, s[16:19], 0 offen offset:96
L2_e3:
    s_mov_b64 exec, -1
    v_pk_sub_u16 v100, v100, v4
    v_pk_sub_u16 v101, v101, v5
    v_pk_sub_u16 v102, v102, v6
    v_pk_sub_u16 v103, v103, v7
    v_cmp_eq_u32 s[56:57], 0, v9
    v_cndmask_b32 v100, 0, v100, vcc
    v_cndmask_b32 v101, 0, v101, vcc
    v_cndmask_b32 v102, 0, v102, vcc
    v_cndmask_b32 v103, 0, v103, vcc
    v_cndmask_b32 v112, 0, v100, s[56:57]
    v_cndmask_b32 v113, 0, v101, s[56:57]
    v_cndmask_b32 v114, 0, v102, s[56:57]
    v_cndmask_b32 v115, 0, v103, s[56:57]
    v_cndmask_b32 v116, 0, v104, s[56:57]
    v_add_u32_dpp v112, v112, v112 row_shr:1 row_mask:0xf bank_mask:0xf
    v_add_u32_dpp v113, v113, v113 row_shr:1 row_mask:0xf bank_mask:0xf
    v_add_u32_dpp v114, v114, v114 row_shr:1 row_mask:0xf bank_mask:0xf
    v_add_u32_dpp v115, v115, v115 row_shr:1 row_mask:0xf bank_mask:0xf
    v_add_u32_dpp v116, v116, v116 row_shr:1 row_mask:0xf bank_mask:0xf
    v_add_u32_dpp v112, v112, v112 row_shr:2 row_mask:0xf bank_mask:0xf
    v_add_u32_dpp v113, v113, v113 row_shr:2 row_mask:0xf bank_mask:0xf
    v_add_u32_dpp v114, v114, v114 row_shr:2 row_mask:0xf bank_mask:0xf
    v_add_u32_dpp v115, v115, v115 row_shr:2 row_mask:0xf bank_mask:0xf
    v_add_u32_dpp v116, v116, v116 row_shr:2 row_mask:0xf bank_mask:0xf
    v_add_u32_dpp v112, v112, v112 row_shr:4 row_mask:0xf bank_mask:0xf
    v_add_u32_dpp v113, v113, v113 row_shr:4 row_mask:0xf bank_mask:0xf
    v_add_u32_dpp v114, v114, v114 row_shr:4 row_mask:0xf bank_mask:0xf
    v_add_u32_dpp v115, v115, v115 row_shr:4 row_mask:0xf bank_mask:0xf
    v_add_u32_dpp v116, v116, v116 row_shr:4 row_mask:0xf bank_mask:0xf
    v_add_u32_dpp v112, v112, v112 row_shr:8 row_mask:0xf bank_mask:0xf
    v_add_u32_dpp v113, v113, v113 row_shr:8 row_mask:0xf bank_mask:0xf
    v_add_u32_dpp v114, v114, v114 row_shr:8 row_mask:0xf bank_mask:0xf
    v_add_u32_dpp v115, v115, v115 row_shr:8 row_mask:0xf bank_mask:0xf
    v_add_u32_dpp v116, v116, v116 row_shr:8 row_mask:0xf bank_mask:0xf
    v_add_u32_dpp v112, v112, v112 row_bcast:15 row_mask:0xa bank_mask:0xf
    v_add_u32_dpp v113, v113, v113 row_bcast:15 row_mask:0xa bank_mask:0xf
    v_add_u32_dpp v114, v114, v114 row_bcast:15 row_mask:0xa bank_mask:0xf
    v_add_u32_dpp v115, v115, v115 row_bcast:15 row_mask:0xa bank_mask:0xf
    v_add_u32_dpp v116, v116, v116 row_bcast:15 row_mask:0xa bank_mask:0xf
    v_add_u32_dpp v112, v112, v112 row_bcast:31 row_mask:0xc bank_mask:0xf
    v_add_u32_dpp v113, v113, v113 row_bcast:31 row_mask:0xc bank_mask:0xf
    v_add_u32_dpp v114, v114, v114 row_bcast:31 row_mask:0xc bank_mask:0xf
    v_add_u32_dpp v115, v115, v115 row_bcast:31 row_mask:0xc bank_mask:0xf
    v_add_u32_dpp v116, v116, v116 row_bcast:31 row_mask:0xc bank_mask:0xf
    s_lshl_b32 s54, s3, 5
    s_add_u32 s54, s54, 156928
    v_mov_b32 v117, s54
    s_mov_b32 s56, 0
    s_brev_b32 s57, 1
    s_mov_b64 exec, s[56:57]
    ds_write_b128 v117, v[112:115]
    ds_write_b32 v117, v116 offset:16
    s_mov_b64 exec, -1
    v_and_b32 v118, 7, v1
    v_lshlrev_b32 v118, 5, v118
    v_add_u32 v118, 156928, v118
    s_waitcnt lgkmcnt(0)
    s_barrier
    ds_read_b128 v[120:123], v118
    ds_read_b32 v124, v118 offset:16
    s_waitcnt lgkmcnt(0)
    v_add_u32_dpp v120, v120, v120 row_shr:1 row_mask:0xf bank_mask:0xf
    v_add_u32_dpp v121, v121, v121 row_shr:1 row_mask:0xf bank_mask:0xf
    v_add_u32_dpp v122, v122, v122 row_shr:1 row_mask:0xf bank_mask:0xf
    v_add_u32_dpp v123, v123, v123 row_shr:1 row_mask:0xf bank_mask:0xf
    v_add_u32_dpp v124, v124, v124 row_shr:1 row_mask:0xf bank_mask:0xf
    v_add_u32_dpp v120, v120, v120 row_shr:2 row_mask:0xf bank_mask:0xf
    v_add_u32_dpp v121, v121, v121 row_shr:2 row_mask:0xf bank_mask:0xf
    v_add_u32_dpp v122, v122, v122 row_shr:2 row_mask:0xf bank_mask:0xf
    v_add_u32_dpp v123, v123, v123 row_shr:2 row_mask:0xf bank_mask:0xf
    v_add_u32_dpp v124, v124, v124 row_shr:2 row_mask:0xf bank_mask:0xf
    v_add_u32_dpp v120, v120, v120 row_shr:4 row_mask:0xf bank_mask:0xf
    v_add_u32_dpp v121, v121, v121 row_shr:4 row_mask:0xf bank_mask:0xf
    v_add_u32_dpp v122, v122, v122 row_shr:4 row_mask:0xf bank_mask:0xf
    v_add_u32_dpp v123, v123, v123 row_shr:4 row_mask:0xf bank_mask:0xf
    v_add_u32_dpp v124, v124, v124 row_shr:4 row_mask:0xf bank_mask:0xf
    v_readlane_b32 s58, v120, 7
    v_readlane_b32 s59, v121, 7
    v_readlane_b32 s60, v122, 7
    v_readlane_b32 s61, v123, 7
    v_readlane_b32 s62, v124, 7
    s_sub_u32 s54, s3, 1
    s_max_i32 s54, s54, 0
    v_readlane_b32 s64, v120, s54
    v_readlane_b32 s65, v121, s54
    v_readlane_b32 s66, v122, s54
    v_readlane_b32 s67, v123, s54
    s_cmp_eq_u32 s3, 0
    s_cselect_b32 s64, 0, s64
    s_cselect_b32 s65, 0, s65
    s_cselect_b32 s66, 0, s66
    s_cselect_b32 s67, 0, s67
    s_and_b32 s68, s58, 0xffff
    s_lshr_b32 s69, s58, 16
    s_and_b32 s70, s59, 0xffff
    s_lshr_b32 s71, s59, 16
    s_and_b32 s72, s60, 0xffff
    s_lshr_b32 s73, s60, 16
    s_and_b32 s74, s61, 0xffff
    s_lshr_b32 s75, s61, 16
    s_mov_b32 s84, 0
    s_mov_b32 s76, s84
    s_add_u32 s54, s68, 31
    s_andn2_b32 s54, s54, 31
    s_add_u32 s84, s84, s54
    s_mov_b32 s77, s84
    s_add_u32 s54, s69, 31
    s_andn2_b32 s54, s54, 31
    s_add_u32 s84, s84, s54
    s_mov_b32 s78, s84
    s_add_u32 s54, s70, 31
    s_andn2_b32 s54, s54, 31
    s_add_u32 s84, s84, s54
    s_mov_b32 s79, s84
    s_add_u32 s54, s71, 31
    s_andn2_b32 s54, s54, 31
    s_add_u32 s84, s84, s54
    s_mov_b32 s80, s84
    s_add_u32 s54, s72, 31
    s_andn2_b32 s54, s54, 31
    s_add_u32 s84, s84, s54
    s_mov_b32 s81, s84
    s_add_u32 s54, s73, 31
    s_andn2_b32 s54, s54, 31
    s_add_u32 s84, s84, s54
    s_mov_b32 s82, s84
    s_add_u32 s54, s74, 31
    s_andn2_b32 s54, s54, 31
    s_add_u32 s84, s84, s54
    s_mov_b32 s83, s84
    s_add_u32 s54, s75, 31
    s_andn2_b32 s54, s54, 31
    s_add_u32 s84, s84, s54
    s_max_u32 s54, s84, s62
    s_cmp_le_u32 s54, 3584
    s_cbranch_scc1 L2_fits
    s_add_u32 s47, s46, 1
    s_waitcnt vmcnt(0) lgkmcnt(0)
    s_branch L2_batch
L2_fits:
    s_cmp_eq_u32 s63, 1
    s_cbranch_scc1 L2_pidone
    s_lshl_b32 s54, s68, 3
    s_add_u32 s90, s54, 7
    v_writelane_b32 v126, s90, 0
    s_lshl_b32 s54, s69, 3
    s_add_u32 s91, s54, 6
    v_writelane_b32 v126, s91, 1
    s_lshl_b32 s54, s70, 3
    s_add_u32 s92, s54, 5
    v_writelane_b32 v126, s92, 2
    s_lshl_b32 s54, s71, 3
    s_add_u32 s93, s54, 4
    v_writelane_b32 v126, s93, 3
    s_lshl_b32 s54, s72, 3
    s_add_u32 s94, s54, 3
    v_writelane_b32 v126, s94, 4
    s_lshl_b32 s54, s73, 3
    s_add_u32 s95, s54, 2
    v_writelane_b32 v126, s95, 5
    s_lshl_b32 s54, s74, 3
    s_add_u32 s96, s54, 1
    v_writelane_b32 v126, s96, 6
    s_lshl_b32 s54, s75, 3
    s_add_u32 s97, s54, 0
    v_writelane_b32 v126, s97, 7
    v_mov_b32 v127, 0
    v_cmp_gt_u32 s[54:55], s90, v126
    v_cmp_gt_u32 s[56:57], s91, v126
    v_cmp_gt_u32 s[58:59], s92, v126
    v_cmp_gt_u32 s[60:61], s93, v126
    v_addc_co_u32 v127, vcc, 0, v127, s[54:55]
    v_addc_co_u32 v127, vcc, 0, v127, s[56:57]
    v_addc_co_u32 v127, vcc, 0, v127, s[58:59]
    v_addc_co_u32 v127, vcc, 0, v127, s[60:61]
    v_cmp_gt_u32 s[54:55], s94, v126
    v_cmp_gt_u32 s[56:57], s95, v126
    v_cmp_gt_u32 s[58:59], s96, v126
    v_cmp_gt_u32 s[60:61], s97, v126
    v_addc_co_u32 v127, vcc, 0, v127, s[54:55]
    v_addc_co_u32 v127, vcc, 0, v127, s[56:57]
    v_addc_co_u32 v127, vcc, 0, v127, s[58:59]
    v_addc_co_u32 v127, vcc, 0, v127, s[60:61]
    s_sub_u32 s54, 11, s3
    s_cmp_lt_u32 s3, 4
    s_cselect_b32 s54, s3, s54
    v_cmp_eq_u32 vcc, s54, v127
    s_nop 3
    s_and_b32 s54, vcc_lo, 0xff
    s_ff1_i32_b32 s101, s54
    s_mul_i32 s53, s2, 49
    s_add_u32 s53, s53, s101
L2_pidone:
    s_mov_b32 s48, s68
    s_mov_b32 s49, s76
    s_cmp_eq_u32 s101, 1
    s_cselect_b32 s48, s69, s48
    s_cselect_b32 s49, s77, s49
    s_cmp_eq_u32 s101, 2
    s_cselect_b32 s48, s70, s48
    s_cselect_b32 s49, s78, s49
    s_cmp_eq_u32 s101, 3
    s_cselect_b32 s48, s71, s48
    s_cselect_b32 s49, s79, s49
    s_cmp_eq_u32 s101, 4
    s_cselect_b32 s48, s72, s48
    s_cselect_b32 s49, s80, s49
    s_cmp_eq_u32 s101, 5
    s_cselect_b32 s48, s73, s48
    s_cselect_b32 s49, s81, s49
    s_cmp_eq_u32 s101, 6
    s_cselect_b32 s48, s74, s48
    s_cselect_b32 s49, s82, s49
    s_cmp_eq_u32 s101, 7
    s_cselect_b32 s48, s75, s48
    s_cselect_b32 s49, s83, s49
    s_add_u32 s50, s48, 31
    s_lshr_b32 s50, s50, 5
    s_pack_ll_b32_b16 s85, s76, s77
    s_add_u32 s85, s85, s64
    s_add_u32 s85, s85, 209718400
    s_pack_ll_b32_b16 s86, s78, s79
    s_add_u32 s86, s86, s65
    s_add_u32 s86, s86, 209718400
    s_pack_ll_b32_b16 s87, s80, s81
    s_add_u32 s87, s87, s66
    s_add_u32 s87, s87, 209718400
    s_pack_ll_b32_b16 s88, s82, s83
    s_add_u32 s88, s88, s67
    s_add_u32 s88, s88, 209718400
    v_lshl_or_b32 v105, v105, 16, v105
    v_mul_u32_u24 v106, 0x100010, v9
    v_sub_u32 v112, v112, v100
    v_add_u32 v112, s85, v112
    v_sub_u32 v120, v4, v105
    v_sub_u32 v112, v112, v120
    v_lshl_add_u32 v112, v112, 2, v106
    v_sub_u32 v113, v113, v101
    v_add_u32 v113, s86, v113
    v_sub_u32 v121, v5, v105
    v_sub_u32 v113, v113, v121
    v_lshl_add_u32 v113, v113, 2, v106
    v_sub_u32 v114, v114, v102
    v_add_u32 v114, s87, v114
    v_sub_u32 v122, v6, v105
    v_sub_u32 v114, v114, v122
    v_lshl_add_u32 v114, v114, 2, v106
    v_sub_u32 v115, v115, v103
    v_add_u32 v115, s88, v115
    v_sub_u32 v123, v7, v105
    v_sub_u32 v115, v115, v123
    v_lshl_add_u32 v115, v115, 2, v106
    v_lshlrev_b32 v108, 4, v0
    v_add_u32 v108, 148736, v108
    ds_write_b128 v108, v[112:115]
    v_mov_b32 v104, v109
    s_mov_b32 s54, 102400
    v_mul_lo_u32 v110, v3, s54
    v_mov_b32 v111, 27136
    v_lshlrev_b32 v96, 4, v1
    s_lshl_b32 s58, s3, 10
    v_add_u32 v96, s58, v96
    s_waitcnt vmcnt(0)
    v_lshlrev_b32 v96, 4, v1
    s_lshl_b32 s58, s3, 10
    v_add_u32 v96, s58, v96
    s_add_u32 m0, s58, 107776
    v_add_u32 v97, 40960, v96
    buffer_load_dwordx4 v97, s[20:23], 0 offen lds
    s_add_u32 m0, s58, 115968
    v_add_u32 v97, 49152, v96
    buffer_load_dwordx4 v97, s[20:23], 0 offen lds
    s_add_u32 m0, s58, 124160
    v_add_u32 v97, 57344, v96
    buffer_load_dwordx4 v97, s[20:23], 0 offen lds
    s_add_u32 m0, s58, 132352
    v_add_u32 v97, 65536, v96
    buffer_load_dwordx4 v97, s[20:23], 0 offen lds
    s_cmp_ge_u32 s3, 2
    s_cbranch_scc1 L2_posdone2
    s_add_u32 m0, s58, 140544
    v_add_u32 v97, 73728, v96
    buffer_load_dwordx4 v97, s[20:23], 0 offen lds
L2_posdone2:
    s_cmp_eq_u32 s63, 1
    s_cbranch_scc1 L2_noA
    s_lshl_b32 s54, s3, 10
    s_add_u32 s55, s54, 142592
    s_add_u32 s54, s54, 154624
    s_cmp_lt_u32 s3, 6
    s_cselect_b32 s62, s55, s54
    v_lshrrev_b32 v120, 3, v1
    v_lshlrev_b32 v120, 3, v120
    v_add_u32 v121, s101, v120
    v_add_u32 v120, s53, v120
    v_cmp_gt_u32 vcc, 49, v121
    v_mov_b32 v122, -1
    v_and_b32 v123, 7, v1
    v_lshlrev_b32 v123, 4, v123
    v_cndmask_b32 v122, v122, v120, vcc
    s_mov_b32 m0, s62
    s_nop 0
    buffer_load_dwordx4 v[122:123], s[40:43], 0 idxen offen lds
L2_noA:
    v_lshrrev_b32 v140, 29, v192
    v_lshl_add_u32 v140, v140, 1, v108
    ds_read_u16 v144, v140
    v_lshrrev_b32 v141, 29, v193
    v_lshl_add_u32 v141, v141, 1, v108
    ds_read_u16 v145, v141
    v_lshrrev_b32 v142, 29, v194
    v_lshl_add_u32 v142, v142, 1, v108
    ds_read_u16 v146, v142
    v_lshrrev_b32 v143, 29, v195
    v_lshl_add_u32 v143, v143, 1, v108
    ds_read_u16 v147, v143
    v_cmp_lt_u32 s[90:91], 0, v104
    v_cmp_lt_u32 s[92:93], 1, v104
    v_cmp_lt_u32 s[94:95], 2, v104
    v_cmp_lt_u32 s[96:97], 3, v104
    s_waitcnt lgkmcnt(0)
    v_cndmask_b32 v144, v111, v144, s[90:91]
    v_cndmask_b32 v145, v111, v145, s[92:93]
    v_cndmask_b32 v146, v111, v146, s[94:95]
    v_cndmask_b32 v147, v111, v147, s[96:97]
    ds_write_b32 v144, v192 offset:15872
    ds_write_b32 v144, v110 offset:37632
    ds_write_b32 v145, v193 offset:15876
    ds_write_b32 v145, v110 offset:37636
    ds_write_b32 v146, v194 offset:15880
    ds_write_b32 v146, v110 offset:37640
    ds_write_b32 v147, v195 offset:15884
    ds_write_b32 v147, v110 offset:37644
    v_cmp_lt_u32 vcc, 8, v104
    s_cbranch_vccz L2_scat_done
    v_lshrrev_b32 v140, 29, v196
    v_lshl_add_u32 v140, v140, 1, v108
    ds_read_u16 v144, v140
    v_lshrrev_b32 v141, 29, v197
    v_lshl_add_u32 v141, v141, 1, v108
    ds_read_u16 v145, v141
    v_lshrrev_b32 v142, 29, v198
    v_lshl_add_u32 v142, v142, 1, v108
    ds_read_u16 v146, v142
    v_lshrrev_b32 v143, 29, v199
    v_lshl_add_u32 v143, v143, 1, v108
    ds_read_u16 v147, v143
    v_cmp_lt_u32 s[90:91], 8, v104
    v_cmp_lt_u32 s[92:93], 9, v104
    v_cmp_lt_u32 s[94:95], 10, v104
    v_cmp_lt_u32 s[96:97], 11, v104
    s_waitcnt lgkmcnt(0)
    v_cndmask_b32 v144, v111, v144, s[90:91]
    v_cndmask_b32 v145, v111, v145, s[92:93]
    v_cndmask_b32 v146, v111, v146, s[94:95]
    v_cndmask_b32 v147, v111, v147, s[96:97]
    ds_write_b32 v144, v196 offset:15904
    ds_write_b32 v144, v110 offset:37664
    ds_write_b32 v145, v197 offset:15908
    ds_write_b32 v145, v110 offset:37668
    ds_write_b32 v146, v198 offset:15912
    ds_write_b32 v146, v110 offset:37672
    ds_write_b32 v147, v199 offset:15916
    ds_write_b32 v147, v110 offset:37676
    v_cmp_lt_u32 vcc, 16, v104
    s_cbranch_vccz L2_scat_done
    v_lshrrev_b32 v140, 29, v200
    v_lshl_add_u32 v140, v140, 1, v108
    ds_read_u16 v144, v140
    v_lshrrev_b32 v141, 29, v201
    v_lshl_add_u32 v141, v141, 1, v108
    ds_read_u16 v145, v141
    v_lshrrev_b32 v142, 29, v202
    v_lshl_add_u32 v142, v142, 1, v108
    ds_read_u16 v146, v142
    v_lshrrev_b32 v143, 29, v203
    v_lshl_add_u32 v143, v143, 1, v108
    ds_read_u16 v147, v143
    v_cmp_lt_u32 s[90:91], 16, v104
    v_cmp_lt_u32 s[92:93], 17, v104
    v_cmp_lt_u32 s[94:95], 18, v104
    v_cmp_lt_u32 s[96:97], 19, v104
    s_waitcnt lgkmcnt(0)
    v_cndmask_b32 v144, v111, v144, s[90:91]
    v_cndmask_b32 v145, v111, v145, s[92:93]
    v_cndmask_b32 v146, v111, v146, s[94:95]
    v_cndmask_b32 v147, v111, v147, s[96:97]
    ds_write_b32 v144, v200 offset:15936
    ds_write_b32 v144, v110 offset:37696
    ds_write_b32 v145, v201 offset:15940
    ds_write_b32 v145, v110 offset:37700
    ds_write_b32 v146, v202 offset:15944
    ds_write_b32 v146, v110 offset:37704
    ds_write_b32 v147, v203 offset:15948
    ds_write_b32 v147, v110 offset:37708
    v_cmp_lt_u32 vcc, 24, v104
    s_cbranch_vccz L2_scat_done
    v_lshrrev_b32 v140, 29, v204
    v_lshl_add_u32 v140, v140, 1, v108
    ds_read_u16 v144, v140
    v_lshrrev_b32 v141, 29, v205
    v_lshl_add_u32 v141, v141, 1, v108
    ds_read_u16 v145, v141
    v_lshrrev_b32 v142, 29, v206
    v_lshl_add_u32 v142, v142, 1, v108
    ds_read_u16 v146, v142
    v_lshrrev_b32 v143, 29, v207
    v_lshl_add_u32 v143, v143, 1, v108
    ds_read_u16 v147, v143
    v_cmp_lt_u32 s[90:91], 24, v104
    v_cmp_lt_u32 s[92:93], 25, v104
    v_cmp_lt_u32 s[94:95], 26, v104
    v_cmp_lt_u32 s[96:97], 27, v104
    s_waitcnt lgkmcnt(0)
    v_cndmask_b32 v144, v111, v144, s[90:91]
    v_cndmask_b32 v145, v111, v145, s[92:93]
    v_cndmask_b32 v146, v111, v146, s[94:95]
    v_cndmask_b32 v147, v111, v147, s[96:97]
    ds_write_b32 v144, v204 offset:15968
    ds_write_b32 v144, v110 offset:37728
    ds_write_b32 v145, v205 offset:15972
    ds_write_b32 v145, v110 offset:37732
    ds_write_b32 v146, v206 offset:15976
    ds_write_b32 v146, v110 offset:37736
    ds_write_b32 v147, v207 offset:15980
    ds_write_b32 v147, v110 offset:37740
    v_cmp_lt_u32 vcc, 32, v104
    s_cbranch_vccz L2_scat_done
    v_subrev_u32 v104, 32, v104
    v_cmp_gt_i32 vcc, 0, v104
    v_mov_b32 v149, 128
    v_add_u32 v107, 128, v107
    v_cndmask_b32 v104, v104, 0, vcc
L2_scat_loop:
    buffer_load_dwordx4 v[192:195], v107, s[16:19], 0 offen
    s_waitcnt vmcnt(0)
    v_lshrrev_b32 v140, 29, v192
    v_lshl_add_u32 v140, v140, 1, v108
    ds_read_u16 v144, v140
    v_lshrrev_b32 v141, 29, v193
    v_lshl_add_u32 v141, v141, 1, v108
    ds_read_u16 v145, v141
    v_lshrrev_b32 v142, 29, v194
    v_lshl_add_u32 v142, v142, 1, v108
    ds_read_u16 v146, v142
    v_lshrrev_b32 v143, 29, v195
    v_lshl_add_u32 v143, v143, 1, v108
    ds_read_u16 v147, v143
    v_cmp_lt_u32 s[90:91], 0, v104
    v_cmp_lt_u32 s[92:93], 1, v104
    v_cmp_lt_u32 s[94:95], 2, v104
    v_cmp_lt_u32 s[96:97], 3, v104
    s_waitcnt lgkmcnt(0)
    v_add_u32 v144, v144, v149
    v_cndmask_b32 v144, v111, v144, s[90:91]
    v_add_u32 v145, v145, v149
    v_cndmask_b32 v145, v111, v145, s[92:93]
    v_add_u32 v146, v146, v149
    v_cndmask_b32 v146, v111, v146, s[94:95]
    v_add_u32 v147, v147, v149
    v_cndmask_b32 v147, v111, v147, s[96:97]
    ds_write_b32 v144, v192 offset:15872
    ds_write_b32 v144, v110 offset:37632
    ds_write_b32 v145, v193 offset:15876
    ds_write_b32 v145, v110 offset:37636
    ds_write_b32 v146, v194 offset:15880
    ds_write_b32 v146, v110 offset:37640
    ds_write_b32 v147, v195 offset:15884
    ds_write_b32 v147, v110 offset:37644
    v_subrev_u32 v104, 8, v104
    v_add_u32 v149, 32, v149
    v_add_u32 v107, 32, v107
    v_cmp_gt_i32 vcc, 0, v104
    s_nop 1
    v_cndmask_b32 v104, v104, 0, vcc
    v_cmp_lt_u32 vcc, 0, v104
    s_cbranch_vccnz L2_scat_loop
L2_scat_done:
    s_waitcnt vmcnt(0) lgkmcnt(0)
    s_barrier
    v_lshrrev_b32 v100, 2, v1
    v_lshlrev_b32 v100, 3, v100
    v_add_u32 v100, s53, v100
    v_mul_u32_u24 v100, 6, v100
    v_and_b32 v102, 3, v1
    v_lshl_add_u32 v100, v102, 1, v100
    v_add_u32 v100, 66816, v100
    ds_read_u16 v101, v100
    s_cmp_eq_u32 s63, 1
    s_cbranch_scc1 L2_noC
    s_mov_b32 s63, 1
    v_lshlrev_b32 v96, 4, v1
    v_add_u32 v96, 158208, v96
    ds_read_b128 v[24:27], v96
    ds_read_b128 v[28:31], v96 offset:1024
    v_and_b32 v120, 31, v1
    v_lshrrev_b32 v121, 5, v1
    v_lshlrev_b32 v122, 2, v120
    v_lshl_add_u32 v122, v121, 9, v122
    v_add_u32 v122, s62, v122
    ds_read_b32 v40, v122 offset:0
    ds_read_b32 v41, v122 offset:128
    ds_read_b32 v42, v122 offset:256
    ds_read_b32 v43, v122 offset:384
    v_lshlrev_b32 v120, 3, v120
    v_add_u32 v120, 160256, v120
    ds_read_b64 v[44:45], v120
    v_cmp_gt_u32 vcc, 32, v1
    s_waitcnt lgkmcnt(0)
    s_nop 0
    v_cndmask_b32 v44, v44, 0, vcc
    v_cndmask_b32 v45, v45, 0, vcc
    v_and_b32 v32, 0xffff, v40
    v_lshrrev_b32 v36, 16, v40
    v_and_b32 v33, 0xffff, v41
    v_lshrrev_b32 v37, 16, v41
    v_and_b32 v34, 0xffff, v42
    v_lshrrev_b32 v38, 16, v42
    v_and_b32 v35, 0xffff, v43
    v_lshrrev_b32 v39, 16, v43
    v_or_b32 v35, v35, v44
    v_or_b32 v39, v39, v45
L2_noC:
    s_lshl_b32 s54, s3, 7
    s_add_u32 s54, s54, 157184
    v_lshlrev_b32 v97, 2, v1
    v_add_u32 v97, s54, v97
    s_waitcnt lgkmcnt(0)
    v_lshlrev_b32 v101, 16, v101
    s_mov_b32 exec_hi, 0
    ds_write_b32 v97, v101
    s_mov_b64 exec, -1
    s_lshl_b32 s54, s3, 7
    s_add_u32 s54, s54, 157184
    v_mov_b32 v98, s54
    v_mov_b32 v99, 66816
    v_add_u32 v96, s49, v1
    v_mov_b32 v97, v1
    s_mov_b32 s51, 0
    s_mov_b32 s55, 0xffff0000
    s_movk_i32 s56, 0x7fff
    s_mov_b32 s38, 12500
    s_mov_b32 s10, 25600000
    s_lshl_b32 s54, s50, 5
    s_sub_u32 s54, s54, 32
    v_add_u32 v100, s54, v1
    v_cmp_le_u32 s[58:59], s48, v100
    v_cmp_gt_u32 vcc, 32, v1
    s_and_b64 vcc, vcc, s[58:59]
    s_cmp_eq_u32 s50, 0
    s_cbranch_scc1 L2_nodummy
    s_and_saveexec_b64 s[58:59], vcc
    s_cbranch_execz L2_dummy_restore
    v_add_u32 v100, s49, v100
    v_lshlrev_b32 v101, 2, v100
    v_mov_b32 v102, 28
    ds_write_b32 v101, v102 offset:28672
    v_lshlrev_b32 v101, 1, v100
    v_mov_b32 v102, 0
    v_mov_b32 v103, 0
    ds_write_b16 v101, v102 offset:43264
    v_lshlrev_b32 v101, 3, v100
    ds_write_b64 v101, v[102:103] offset:0
L2_dummy_restore:
    s_mov_b64 exec, s[58:59]
L2_nodummy:
    v_lshlrev_b32 v96, 2, v96
    v_sub_u32 v97, s48, v97
    s_movk_i32 s57, 128
    s_movk_i32 s54, 192
    s_cmp_eq_u32 s48, 0
    s_cbranch_scc1 L2_geo_done
    ds_read_b32 v113, v96 offset:28672
    ds_read_b32 v114, v96 offset:50432
    ds_read_b32 v133, v96 offset:28928
    ds_read_b32 v134, v96 offset:50688
    ds_read_b32 v153, v96 offset:29184
    ds_read_b32 v154, v96 offset:50944
    ds_read_b32 v173, v96 offset:29440
    ds_read_b32 v174, v96 offset:51200
    v_lshrrev_b32 v104, 1, v96
    v_lshlrev_b32 v105, 1, v96
    v_cmp_lt_i32 s[90:91], 0, v97
    v_cmp_lt_i32 s[92:93], 64, v97
    v_cmp_lt_i32 s[94:95], s57, v97
    v_cmp_lt_i32 s[96:97], s54, v97
    s_waitcnt lgkmcnt(6)
    v_bfe_u32 v115, v113, 15, 14
    v_and_b32 v116, 7, v113
    v_mad_u32_u24 v117, v115, 6, v99
    v_lshl_add_u32 v119, v116, 4, v98
    v_and_b32 v117, -4, v117
    ds_read_b96 v[120:122], v119
    ds_read2_b32 v[124:125], v117 offset1:1
    v_and_b32 v117, s56, v113
    v_lshl_add_u32 v114, v117, 2, v114
    v_lshlrev_b32 v118, 4, v115
    s_waitcnt lgkmcnt(6)
    v_bfe_u32 v135, v133, 15, 14
    v_and_b32 v136, 7, v133
    v_mad_u32_u24 v137, v135, 6, v99
    v_lshl_add_u32 v139, v136, 4, v98
    v_and_b32 v137, -4, v137
    ds_read_b96 v[140:142], v139
    ds_read2_b32 v[144:145], v137 offset1:1
    v_and_b32 v137, s56, v133
    v_lshl_add_u32 v134, v137, 2, v134
    v_lshlrev_b32 v138, 4, v135
    s_waitcnt lgkmcnt(6)
    v_bfe_u32 v155, v153, 15, 14
    v_and_b32 v156, 7, v153
    v_mad_u32_u24 v157, v155, 6, v99
    v_lshl_add_u32 v159, v156, 4, v98
    v_and_b32 v157, -4, v157
    ds_read_b96 v[160:162], v159
    ds_read2_b32 v[164:165], v157 offset1:1
    v_and_b32 v157, s56, v153
    v_lshl_add_u32 v154, v157, 2, v154
    v_lshlrev_b32 v158, 4, v155
    s_waitcnt lgkmcnt(6)
    v_bfe_u32 v175, v173, 15, 14
    v_and_b32 v176, 7, v173
    v_mad_u32_u24 v177, v175, 6, v99
    v_lshl_add_u32 v179, v176, 4, v98
    v_and_b32 v177, -4, v177
    ds_read_b96 v[180:182], v179
    ds_read2_b32 v[184:185], v177 offset1:1
    v_and_b32 v177, s56, v173
    v_lshl_add_u32 v174, v177, 2, v174
    v_lshlrev_b32 v178, 4, v175
    v_and_b32 v48, s89, v114
    v_mov_b32 v51, 0
    v_mov_b32 v50, v115
    s_mov_b32 exec_hi, 0
    buffer_load_dword v48, v48, s[8:11], 0 offen
    buffer_load_dword v49, v[50:51], s[36:39], 0 idxen offen
    s_mov_b64 exec, -1
    s_waitcnt lgkmcnt(6)
    v_alignbit_b32 v116, v125, v124, v118
    v_lshrrev_b32 v119, v118, v125
    v_lshlrev_b32 v117, 16, v116
    v_and_b32 v116, s55, v116
    v_lshlrev_b32 v119, 16, v119
    v_sub_f32 v117, v120, v117
    v_sub_f32 v116, v121, v116
    v_sub_f32 v119, v122, v119
    v_mul_f32 v129, v117, v117
    v_cvt_pk_bf16_f32 v127, v116, v119
    v_fmac_f32 v129, v116, v116
    v_fmac_f32 v129, v119, v119
    s_mov_b64 exec, s[90:91]
    ds_write_b32 v96, v114 offset:28672
    v_cvt_pk_bf16_f32 v126, v129, v117
    ds_write_b16 v104, v115 offset:43264
    ds_write_b64 v105, v[126:127] offset:0
    s_mov_b64 exec, -1
    s_waitcnt lgkmcnt(7)
    v_alignbit_b32 v136, v145, v144, v138
    v_lshrrev_b32 v139, v138, v145
    v_lshlrev_b32 v137, 16, v136
    v_and_b32 v136, s55, v136
    v_lshlrev_b32 v139, 16, v139
    v_sub_f32 v137, v140, v137
    v_sub_f32 v136, v141, v136
    v_sub_f32 v139, v142, v139
    v_mul_f32 v149, v137, v137
    v_cvt_pk_bf16_f32 v147, v136, v139
    v_fmac_f32 v149, v136, v136
    v_fmac_f32 v149, v139, v139
    s_mov_b64 exec, s[92:93]
    ds_write_b32 v96, v134 offset:28928
    v_cvt_pk_bf16_f32 v146, v149, v137
    ds_write_b16 v104, v135 offset:43392
    ds_write_b64 v105, v[146:147] offset:512
    s_mov_b64 exec, -1
    s_waitcnt lgkmcnt(8)
    v_alignbit_b32 v156, v165, v164, v158
    v_lshrrev_b32 v159, v158, v165
    v_lshlrev_b32 v157, 16, v156
    v_and_b32 v156, s55, v156
    v_lshlrev_b32 v159, 16, v159
    v_sub_f32 v157, v160, v157
    v_sub_f32 v156, v161, v156
    v_sub_f32 v159, v162, v159
    v_mul_f32 v169, v157, v157
    v_cvt_pk_bf16_f32 v167, v156, v159
    v_fmac_f32 v169, v156, v156
    v_fmac_f32 v169, v159, v159
    s_mov_b64 exec, s[94:95]
    ds_write_b32 v96, v154 offset:29184
    v_cvt_pk_bf16_f32 v166, v169, v157
    ds_write_b16 v104, v155 offset:43520
    ds_write_b64 v105, v[166:167] offset:1024
    s_mov_b64 exec, -1
    s_waitcnt lgkmcnt(9)
    v_alignbit_b32 v176, v185, v184, v178
    v_lshrrev_b32 v179, v178, v185
    v_lshlrev_b32 v177, 16, v176
    v_and_b32 v176, s55, v176
    v_lshlrev_b32 v179, 16, v179
    v_sub_f32 v177, v180, v177
    v_sub_f32 v176, v181, v176
    v_sub_f32 v179, v182, v179
    v_mul_f32 v189, v177, v177
    v_cvt_pk_bf16_f32 v187, v176, v179
    v_fmac_f32 v189, v176, v176
    v_fmac_f32 v189, v179, v179
    s_mov_b64 exec, s[96:97]
    ds_write_b32 v96, v174 offset:29440
    v_cvt_pk_bf16_f32 v186, v189, v177
    ds_write_b16 v104, v175 offset:43648
    ds_write_b64 v105, v[186:187] offset:1536
    s_mov_b64 exec, -1
    v_add_u32 v96, 1024, v96
    v_subrev_u32 v97, 256, v97
    s_add_u32 s51, s51, 256
L2_geo_loop:
    s_cmp_ge_u32 s51, s48
    s_cbranch_scc1 L2_geo_done
    ds_read_b32 v113, v96 offset:28672
    ds_read_b32 v114, v96 offset:50432
    ds_read_b32 v133, v96 offset:28928
    ds_read_b32 v134, v96 offset:50688
    ds_read_b32 v153, v96 offset:29184
    ds_read_b32 v154, v96 offset:50944
    v_lshrrev_b32 v104, 1, v96
    v_lshlrev_b32 v105, 1, v96
    v_cmp_lt_i32 s[90:91], 0, v97
    v_cmp_lt_i32 s[92:93], 64, v97
    v_cmp_lt_i32 s[94:95], s57, v97
    s_waitcnt lgkmcnt(4)
    v_bfe_u32 v115, v113, 15, 14
    v_and_b32 v116, 7, v113
    v_mad_u32_u24 v117, v115, 6, v99
    v_lshl_add_u32 v119, v116, 4, v98
    v_and_b32 v117, -4, v117
    ds_read_b96 v[120:122], v119
    ds_read2_b32 v[124:125], v117 offset1:1
    v_and_b32 v117, s56, v113
    v_lshl_add_u32 v114, v117, 2, v114
    v_lshlrev_b32 v118, 4, v115
    s_waitcnt lgkmcnt(4)
    v_bfe_u32 v135, v133, 15, 14
    v_and_b32 v136, 7, v133
    v_mad_u32_u24 v137, v135, 6, v99
    v_lshl_add_u32 v139, v136, 4, v98
    v_and_b32 v137, -4, v137
    ds_read_b96 v[140:142], v139
    ds_read2_b32 v[144:145], v137 offset1:1
    v_and_b32 v137, s56, v133
    v_lshl_add_u32 v134, v137, 2, v134
    v_lshlrev_b32 v138, 4, v135
    s_waitcnt lgkmcnt(4)
    v_bfe_u32 v155, v153, 15, 14
    v_and_b32 v156, 7, v153
    v_mad_u32_u24 v157, v155, 6, v99
    v_lshl_add_u32 v159, v156, 4, v98
    v_and_b32 v157, -4, v157
    ds_read_b96 v[160:162], v159
    ds_read2_b32 v[164:165], v157 offset1:1
    v_and_b32 v157, s56, v153
    v_lshl_add_u32 v154, v157, 2, v154
    v_lshlrev_b32 v158, 4, v155
    s_waitcnt lgkmcnt(4)
    v_alignbit_b32 v116, v125, v124, v118
    v_lshrrev_b32 v119, v118, v125
    v_lshlrev_b32 v117, 16, v116
    v_and_b32 v116, s55, v116
    v_lshlrev_b32 v119, 16, v119
    v_sub_f32 v117, v120, v117
    v_sub_f32 v116, v121, v116
    v_sub_f32 v119, v122, v119
    v_mul_f32 v129, v117, v117
    v_cvt_pk_bf16_f32 v127, v116, v119
    v_fmac_f32 v129, v116, v116
    v_fmac_f32 v129, v119, v119
    s_mov_b64 exec, s[90:91]
    ds_write_b32 v96, v114 offset:28672
    v_cvt_pk_bf16_f32 v126, v129, v117
    ds_write_b16 v104, v115 offset:43264
    ds_write_b64 v105, v[126:127] offset:0
    s_mov_b64 exec, -1
    s_waitcnt lgkmcnt(5)
    v_alignbit_b32 v136, v145, v144, v138
    v_lshrrev_b32 v139, v138, v145
    v_lshlrev_b32 v137, 16, v136
    v_and_b32 v136, s55, v136
    v_lshlrev_b32 v139, 16, v139
    v_sub_f32 v137, v140, v137
    v_sub_f32 v136, v141, v136
    v_sub_f32 v139, v142, v139
    v_mul_f32 v149, v137, v137
    v_cvt_pk_bf16_f32 v147, v136, v139
    v_fmac_f32 v149, v136, v136
    v_fmac_f32 v149, v139, v139
    s_mov_b64 exec, s[92:93]
    ds_write_b32 v96, v134 offset:28928
    v_cvt_pk_bf16_f32 v146, v149, v137
    ds_write_b16 v104, v135 offset:43392
    ds_write_b64 v105, v[146:147] offset:512
    s_mov_b64 exec, -1
    s_waitcnt lgkmcnt(6)
    v_alignbit_b32 v156, v165, v164, v158
    v_lshrrev_b32 v159, v158, v165
    v_lshlrev_b32 v157, 16, v156
    v_and_b32 v156, s55, v156
    v_lshlrev_b32 v159, 16, v159
    v_sub_f32 v157, v160, v157
    v_sub_f32 v156, v161, v156
    v_sub_f32 v159, v162, v159
    v_mul_f32 v169, v157, v157
    v_cvt_pk_bf16_f32 v167, v156, v159
    v_fmac_f32 v169, v156, v156
    v_fmac_f32 v169, v159, v159
    s_mov_b64 exec, s[94:95]
    ds_write_b32 v96, v154 offset:29184
    v_cvt_pk_bf16_f32 v166, v169, v157
    ds_write_b16 v104, v155 offset:43520
    ds_write_b64 v105, v[166:167] offset:1024
    s_mov_b64 exec, -1
    v_add_u32 v96, 768, v96
    v_subrev_u32 v97, 192, v97
    s_add_u32 s51, s51, 192
    s_branch L2_geo_loop
L2_geo_done:
    v_lshrrev_b32 v97, 3, v1
    v_add_u32 v97, s49, v97
    v_lshlrev_b32 v97, 1, v97
    v_add_u32 v248, 43264, v97
    v_lshrrev_b32 v97, 1, v1
    v_add_u32 v97, s49, v97
    v_lshlrev_b32 v97, 2, v97
    v_add_u32 v249, 28672, v97
    v_and_b32 v97, 31, v1
    v_add_u32 v97, s49, v97
    v_lshlrev_b32 v98, 2, v97
    v_add_u32 v250, 28672, v98
    v_lshrrev_b32 v98, 5, v1
    v_lshlrev_b32 v98, 2, v98
    v_lshl_add_u32 v98, v97, 3, v98
    v_add_u32 v251, 0, v98
    s_mov_b32 s51, 0
    s_sub_u32 s86, s50, 3
    s_sub_u32 s87, s50, 1
    s_sub_u32 s88, s50, 2
    ds_read_u16 v240, v248 offset:0
    ds_read_u16 v242, v248 offset:16
    ds_read_u16 v244, v248 offset:32
    ds_read_u16 v246, v248 offset:48
    ds_read_b32 v10, v249
    ds_read_b32 v252, v250
    ds_read_b32 v253, v251
    v_cvt_f32_u32 v96, s50
    v_rcp_f32 v96, v96
    s_nop 0
    v_mul_f32 v96, 1237319680, v96
    v_cvt_u32_f32 v96, v96
    s_nop 0
    v_readfirstlane_b32 s85, v96
    s_mov_b32 s84, 0
    s_sub_u32 s84, s84, s85
    s_lshl_b32 s54, s3, 11
    s_add_u32 s54, s54, 50432
    v_lshlrev_b32 v96, 4, v1
    v_add_u32 v96, s54, v96
    v_mov_b32 v100, 0
    v_mov_b32 v101, 0
    v_mov_b32 v102, 0
    v_mov_b32 v103, 0
    v_and_or_b32 v11, v10, s89, v238
    s_waitcnt lgkmcnt(0)
    s_barrier
    ds_write_b128 v96, v[100:103]
    ds_write_b128 v96, v[100:103] offset:1024
    s_cmp_eq_u32 s50, 0
    s_cbranch_scc1 L2_notiles
    s_mov_b32 s38, 12500
    s_mov_b32 s10, 25600000
    v_and_or_b32 v11, v10, s89, v238
    s_add_u32 m0, s52, 4096
    s_nop 0
    buffer_load_dwordx4 v11, s[8:11], 0 offen lds
    s_add_u32 m0, s52, 0
    s_nop 0
    buffer_load_dwordx4 v[240:241], s[36:39], 0 idxen offen lds
    s_add_u32 m0, s52, 1024
    s_nop 0
    buffer_load_dwordx4 v[242:243], s[36:39], 0 idxen offen lds
    s_add_u32 m0, s52, 2048
    s_nop 0
    buffer_load_dwordx4 v[244:245], s[36:39], 0 idxen offen lds
    s_add_u32 m0, s52, 3072
    s_nop 0
    buffer_load_dwordx4 v[246:247], s[36:39], 0 idxen offen lds
    ds_read_u16 v240, v248 offset:64
    ds_read_u16 v242, v248 offset:80
    ds_read_u16 v244, v248 offset:96
    ds_read_u16 v246, v248 offset:112
    ds_read_b32 v10, v249 offset:128
    s_cmp_lt_u32 s50, 2
    s_cbranch_scc1 L2_nod1
    s_waitcnt lgkmcnt(0)
    v_and_or_b32 v11, v10, s89, v238
    s_add_u32 m0, s52, 9216
    s_nop 0
    buffer_load_dwordx4 v11, s[8:11], 0 offen lds
    s_add_u32 m0, s52, 5120
    s_nop 0
    buffer_load_dwordx4 v[240:241], s[36:39], 0 idxen offen lds
    s_add_u32 m0, s52, 6144
    s_nop 0
    buffer_load_dwordx4 v[242:243], s[36:39], 0 idxen offen lds
    s_add_u32 m0, s52, 7168
    s_nop 0
    buffer_load_dwordx4 v[244:245], s[36:39], 0 idxen offen lds
    s_add_u32 m0, s52, 8192
    s_nop 0
    buffer_load_dwordx4 v[246:247], s[36:39], 0 idxen offen lds
L2_nod1:
    ds_read_u16 v240, v248 offset:128
    ds_read_u16 v242, v248 offset:144
    ds_read_u16 v244, v248 offset:160
    ds_read_u16 v246, v248 offset:176
    ds_read_b32 v10, v249 offset:256
    v_and_b32 v97, 31, v1
    v_lshrrev_b32 v98, 5, v1
    v_bfe_u32 v99, v97, 1, 3
    v_lshlrev_b32 v100, 7, v97
    v_add_u32 v100, s52, v100
    v_add_u32 v101, 0, v98
    v_xor_b32 v101, v101, v99
    v_lshl_add_u32 v228, v101, 4, v100
    v_add_u32 v101, 2, v98
    v_xor_b32 v101, v101, v99
    v_lshl_add_u32 v229, v101, 4, v100
    v_add_u32 v101, 4, v98
    v_xor_b32 v101, v101, v99
    v_lshl_add_u32 v230, v101, 4, v100
    v_add_u32 v101, 6, v98
    v_xor_b32 v101, v101, v99
    v_lshl_add_u32 v231, v101, 4, v100
    v_lshrrev_b32 v101, 4, v97
    v_xor_b32 v101, v101, v98
    v_lshlrev_b32 v101, 4, v101
    v_lshl_add_u32 v101, v97, 5, v101
    v_add_u32 v101, s52, v101
    v_add_u32 v232, 4096, v101
    s_lshl_b32 s57, s3, 11
    s_add_u32 s57, s57, 50432
    v_lshlrev_b32 v101, 6, v97
    v_add_u32 v101, s57, v101
    v_bfe_u32 v102, v97, 2, 2
    v_xor_b32 v103, v98, v102
    v_lshl_add_u32 v233, v103, 4, v101
    v_lshlrev_b32 v103, 1, v98
    v_xor_b32 v104, v103, v102
    v_lshl_add_u32 v234, v104, 4, v101
    v_add_u32 v103, 1, v103
    v_xor_b32 v104, v103, v102
    v_lshl_add_u32 v104, v104, 4, v101
    v_add_u32 v14, 12, v104
    v_cmp_gt_u32 vcc, 32, v1
    v_mov_b32 v103, 0xffff0000
    v_mov_b32 v104, -1
    v_cndmask_b32 v237, v104, v103, vcc
    v_mov_b32 v239, 0x3f80
    v_mov_b32 v225, 0
    v_mov_b32 v226, 0
    v_mov_b32 v227, 0
    v_cndmask_b32 v224, 0, v239, vcc
    v_lshlrev_b32 v101, 3, v98
    v_sub_u32 v101, v97, v101
    v_and_b32 v102, 1, v101
    v_lshlrev_b32 v102, 4, v102
    v_lshlrev_b32 v102, v102, v239
    v_ashrrev_i32 v101, 1, v101
    v_cmp_eq_u32 s[90:91], 0, v101
    v_cmp_eq_u32 s[92:93], 1, v101
    v_cmp_eq_u32 s[94:95], 2, v101
    v_cmp_eq_u32 s[96:97], 3, v101
    v_cndmask_b32 v16, 0, v102, s[90:91]
    v_cndmask_b32 v17, 0, v102, s[92:93]
    v_cndmask_b32 v18, 0, v102, s[94:95]
    v_cndmask_b32 v19, 0, v102, s[96:97]
    v_cmp_eq_u32 s[90:91], 8, v101
    v_cmp_eq_u32 s[92:93], 9, v101
    v_cmp_eq_u32 s[94:95], 10, v101
    v_cmp_eq_u32 s[96:97], 11, v101
    v_cndmask_b32 v20, 0, v102, s[90:91]
    v_cndmask_b32 v21, 0, v102, s[92:93]
    v_cndmask_b32 v22, 0, v102, s[94:95]
    v_cndmask_b32 v23, 0, v102, s[96:97]
    v_and_b32 v101, 15, v1
    v_lshrrev_b32 v101, 2, v101
    v_lshl_add_u32 v101, v98, 2, v101
    v_lshlrev_b32 v101, 6, v101
    v_and_b32 v102, 1, v1
    v_lshl_add_u32 v101, v102, 3, v101
    v_add_u32 v101, s57, v101
    v_bfe_u32 v102, v1, 4, 1
    v_bfe_u32 v103, v1, 1, 1
    v_lshl_add_u32 v102, v102, 1, v103
    v_xor_b32 v103, v102, v98
    v_lshl_add_u32 v235, v103, 4, v101
    v_add_u32 v103, 2, v98
    v_xor_b32 v103, v102, v103
    v_lshl_add_u32 v103, v103, 4, v101
    v_add_u32 v15, 512, v103
    v_bitop3_b32 v254, v252, 28, v234 bitop3:0x6a
    v_bfi_b32 v40, v237, v253, v239
    v_perm_b32 v41, v253, v253, s100
    ds_write_b32 v254, v40
    ds_write_b32 v14, v41
    ds_read_b128 v[212:215], v233
    s_cmp_gt_u32 s50, 1
    s_waitcnt vmcnt(5)
    s_cbranch_scc1 L2_w1
    s_waitcnt vmcnt(0)
L2_w1:
    ds_read_b128 v[192:195], v228 offset:0
    ds_read_b128 v[196:199], v229 offset:0
    ds_read_b128 v[200:203], v230 offset:0
    ds_read_b128 v[204:207], v231 offset:0
    ds_read_b128 v[208:211], v232 offset:0
    ds_read_b32 v252, v250 offset:128
    ds_read_b32 v253, v251 offset:256
    s_waitcnt lgkmcnt(0)
    v_mfma_f32_32x32x16_bf16 v[96:111], v[192:195], v[16:19], 0
    v_mfma_f32_32x32x16_bf16 v[96:111], v[196:199], v[20:23], v[96:111]
    v_mfma_f32_32x32x16_bf16 v[96:111], v[208:211], v[24:27], v[96:111]
    v_mfma_f32_32x32x16_bf16 v[96:111], v[212:215], v[32:35], v[96:111]
    v_mfma_f32_32x32x16_bf16 v[112:127], v[200:203], v[16:19], 0
    v_mfma_f32_32x32x16_bf16 v[112:127], v[204:207], v[20:23], v[112:127]
    v_mfma_f32_32x32x16_bf16 v[112:127], v[208:211], v[28:31], v[112:127]
    v_mfma_f32_32x32x16_bf16 v[112:127], v[212:215], v[36:39], v[112:127]
L2_s0:
    s_cmp_ge_i32 s51, s87
    s_cbranch_scc1 L2_l0
    s_add_u32 s84, s84, s85
    s_bitcmp1_b32 s84, 17
    s_cbranch_scc1 Lp0h
    s_bitcmp1_b32 s84, 16
    s_cbranch_scc1 Lp0a
    s_setprio 3
    s_branch Lp0z
Lp0a:
    s_setprio 2
    s_branch Lp0z
Lp0h:
    s_bitcmp1_b32 s84, 16
    s_cbranch_scc1 Lp0b
    s_setprio 1
    s_branch Lp0z
Lp0b:
    s_setprio 0
Lp0z:
    v_exp_f32 v160, v96
    s_cmp_lg_u32 s51, 0
    s_cbranch_scc1 Ld1
    s_cmp_lt_u32 s50, 3
    s_cbranch_scc1 Ld1
    v_and_or_b32 v11, v10, s89, v238
    s_add_u32 m0, s52, 4096
    s_nop 0
    buffer_load_dwordx4 v11, s[8:11], 0 offen lds
    s_add_u32 m0, s52, 0
    s_nop 0
    buffer_load_dwordx4 v[240:241], s[36:39], 0 idxen offen lds
    s_add_u32 m0, s52, 1024
    s_nop 0
    buffer_load_dwordx4 v[242:243], s[36:39], 0 idxen offen lds
    s_add_u32 m0, s52, 2048
    s_nop 0
    buffer_load_dwordx4 v[244:245], s[36:39], 0 idxen offen lds
    s_add_u32 m0, s52, 3072
    s_nop 0
    buffer_load_dwordx4 v[246:247], s[36:39], 0 idxen offen lds
Ld1:
    ds_read_b64_tr_b16 v[216:217], v235 offset:0
    v_exp_f32 v161, v97
    v_exp_f32 v162, v98
    ds_read_b64_tr_b16 v[218:219], v15 offset:0
    v_exp_f32 v163, v99
    v_exp_f32 v164, v100
    ds_read_b64_tr_b16 v[220:221], v235 offset:1024
    v_exp_f32 v165, v101
    v_exp_f32 v166, v102
    ds_read_b64_tr_b16 v[222:223], v15 offset:1024
    v_exp_f32 v167, v103
    v_exp_f32 v168, v104
    ds_write_b32 v254, v225
    v_exp_f32 v169, v105
    v_bitop3_b32 v254, v252, 28, v234 bitop3:0x6a
    v_exp_f32 v170, v106
    v_bfi_b32 v40, v237, v253, v239
    v_exp_f32 v171, v107
    v_perm_b32 v41, v253, v253, s100
    v_exp_f32 v172, v108
    ds_write_b32 v254, v40
    v_exp_f32 v173, v109
    ds_write_b32 v14, v41
    v_exp_f32 v174, v110
    ds_read_b128 v[212:215], v233
    v_exp_f32 v175, v111
    v_exp_f32 v176, v112
    s_cmp_lt_i32 s51, s88
    s_waitcnt vmcnt(5)
    s_cbranch_scc1 Lw2
    s_waitcnt vmcnt(0)
Lw2:
    ds_read_b128 v[192:195], v228 offset:5120
    v_exp_f32 v177, v113
    v_mfma_f32_32x32x16_bf16 v[160:175], v[224:227], v[224:227], v[160:175]
    v_exp_f32 v178, v114
    ds_read_b128 v[196:199], v229 offset:5120
    v_exp_f32 v179, v115
    v_exp_f32 v180, v116
    ds_read_b128 v[200:203], v230 offset:5120
    v_exp_f32 v181, v117
    v_exp_f32 v182, v118
    ds_read_b128 v[204:207], v231 offset:5120
    v_exp_f32 v183, v119
    v_exp_f32 v184, v120
    ds_read_b128 v[208:211], v232 offset:5120
    v_exp_f32 v185, v121
    v_exp_f32 v186, v122
    ds_read_b32 v252, v250 offset:256
    v_exp_f32 v187, v123
    ds_read_b32 v253, v251 offset:512
    v_exp_f32 v188, v124
    ds_read_u16 v240, v248 offset:192
    v_exp_f32 v189, v125
    ds_read_u16 v242, v248 offset:208
    v_exp_f32 v190, v126
    ds_read_u16 v244, v248 offset:224
    v_exp_f32 v191, v127
    ds_read_u16 v246, v248 offset:240
    v_rcp_f32 v160, v160
    ds_read_b32 v10, v249 offset:384
    v_rcp_f32 v161, v161
    v_mfma_f32_32x32x16_bf16 v[176:191], v[224:227], v[224:227], v[176:191]
    v_rcp_f32 v162, v162
    v_rcp_f32 v163, v163
    v_rcp_f32 v164, v164
    s_waitcnt lgkmcnt(0)
    v_rcp_f32 v165, v165
    s_cmp_lt_i32 s51, s86
    s_cbranch_scc0 Lnd3
    v_and_or_b32 v11, v10, s89, v238
    s_add_u32 m0, s52, 9216
    s_nop 0
    buffer_load_dwordx4 v11, s[8:11], 0 offen lds
    s_add_u32 m0, s52, 5120
    s_nop 0
    buffer_load_dwordx4 v[240:241], s[36:39], 0 idxen offen lds
    s_add_u32 m0, s52, 6144
    s_nop 0
    buffer_load_dwordx4 v[242:243], s[36:39], 0 idxen offen lds
    s_add_u32 m0, s52, 7168
    s_nop 0
    buffer_load_dwordx4 v[244:245], s[36:39], 0 idxen offen lds
    s_add_u32 m0, s52, 8192
    s_nop 0
    buffer_load_dwordx4 v[246:247], s[36:39], 0 idxen offen lds
Lnd3:
    v_mfma_f32_32x32x16_bf16 v[128:143], v[192:195], v[16:19], 0
    v_rcp_f32 v166, v166
    v_rcp_f32 v167, v167
    v_rcp_f32 v168, v168
    v_mfma_f32_32x32x16_bf16 v[128:143], v[196:199], v[20:23], v[128:143]
    v_rcp_f32 v169, v169
    v_rcp_f32 v170, v170
    v_rcp_f32 v171, v171
    v_mfma_f32_32x32x16_bf16 v[128:143], v[208:211], v[24:27], v[128:143]
    v_rcp_f32 v172, v172
    v_rcp_f32 v173, v173
    v_rcp_f32 v174, v174
    v_mfma_f32_32x32x16_bf16 v[128:143], v[212:215], v[32:35], v[128:143]
    v_rcp_f32 v175, v175
    v_rcp_f32 v176, v176
    v_rcp_f32 v177, v177
    v_mfma_f32_32x32x16_bf16 v[144:159], v[200:203], v[16:19], 0
    v_rcp_f32 v178, v178
    v_rcp_f32 v179, v179
    v_rcp_f32 v180, v180
    v_mfma_f32_32x32x16_bf16 v[144:159], v[204:207], v[20:23], v[144:159]
    v_rcp_f32 v181, v181
    v_rcp_f32 v182, v182
    v_rcp_f32 v183, v183
    v_mfma_f32_32x32x16_bf16 v[144:159], v[208:211], v[28:31], v[144:159]
    v_rcp_f32 v184, v184
    v_rcp_f32 v185, v185
    v_rcp_f32 v186, v186
    v_mfma_f32_32x32x16_bf16 v[144:159], v[212:215], v[36:39], v[144:159]
    v_rcp_f32 v187, v187
    v_rcp_f32 v188, v188
    v_rcp_f32 v189, v189
    v_rcp_f32 v190, v190
    v_rcp_f32 v191, v191
    v_pk_mul_f32 v[160:161], v[160:161], v[96:97]
    v_pk_mul_f32 v[162:163], v[162:163], v[98:99]
    v_pk_mul_f32 v[164:165], v[164:165], v[100:101]
    v_pk_mul_f32 v[166:167], v[166:167], v[102:103]
    v_pk_mul_f32 v[168:169], v[168:169], v[104:105]
    v_pk_mul_f32 v[170:171], v[170:171], v[106:107]
    v_pk_mul_f32 v[172:173], v[172:173], v[108:109]
    v_pk_mul_f32 v[174:175], v[174:175], v[110:111]
    v_pk_mul_f32 v[176:177], v[176:177], v[112:113]
    v_pk_mul_f32 v[178:179], v[178:179], v[114:115]
    v_pk_mul_f32 v[180:181], v[180:181], v[116:117]
    v_pk_mul_f32 v[182:183], v[182:183], v[118:119]
    v_pk_mul_f32 v[184:185], v[184:185], v[120:121]
    v_pk_mul_f32 v[186:187], v[186:187], v[122:123]
    v_pk_mul_f32 v[188:189], v[188:189], v[124:125]
    v_pk_mul_f32 v[190:191], v[190:191], v[126:127]
    v_cvt_pk_bf16_f32 v96, v160, v161
    v_cvt_pk_bf16_f32 v97, v162, v163
    v_cvt_pk_bf16_f32 v98, v164, v165
    v_cvt_pk_bf16_f32 v99, v166, v167
    v_cvt_pk_bf16_f32 v100, v168, v169
    v_cvt_pk_bf16_f32 v101, v170, v171
    v_mfma_f32_32x32x16_bf16 v[64:79], v[96:99], v[216:219], v[64:79]
    v_cvt_pk_bf16_f32 v102, v172, v173
    v_cvt_pk_bf16_f32 v103, v174, v175
    v_cvt_pk_bf16_f32 v104, v176, v177
    v_cvt_pk_bf16_f32 v105, v178, v179
    v_mfma_f32_32x32x16_bf16 v[64:79], v[100:103], v[220:223], v[64:79]
    v_cvt_pk_bf16_f32 v106, v180, v181
    v_cvt_pk_bf16_f32 v107, v182, v183
    v_cvt_pk_bf16_f32 v108, v184, v185
    v_cvt_pk_bf16_f32 v109, v186, v187
    v_mfma_f32_32x32x16_bf16 v[80:95], v[104:107], v[216:219], v[80:95]
    v_cvt_pk_bf16_f32 v110, v188, v189
    v_cvt_pk_bf16_f32 v111, v190, v191
    s_nop 1
    v_mfma_f32_32x32x16_bf16 v[80:95], v[108:111], v[220:223], v[80:95]
    s_add_u32 s51, s51, 1
L2_s1:
    s_cmp_ge_i32 s51, s87
    s_cbranch_scc1 L2_l1
    v_exp_f32 v160, v128
    ds_read_b64_tr_b16 v[216:217], v235 offset:0
    v_exp_f32 v161, v129
    v_exp_f32 v162, v130
    ds_read_b64_tr_b16 v[218:219], v15 offset:0
    v_exp_f32 v163, v131
    v_exp_f32 v164, v132
    ds_read_b64_tr_b16 v[220:221], v235 offset:1024
    v_exp_f32 v165, v133
    v_exp_f32 v166, v134
    ds_read_b64_tr_b16 v[222:223], v15 offset:1024
    v_exp_f32 v167, v135
    v_exp_f32 v168, v136
    ds_write_b32 v254, v225
    v_exp_f32 v169, v137
    v_bitop3_b32 v254, v252, 28, v234 bitop3:0x6a
    v_exp_f32 v170, v138
    v_bfi_b32 v40, v237, v253, v239
    v_exp_f32 v171, v139
    v_perm_b32 v41, v253, v253, s100
    v_exp_f32 v172, v140
    ds_write_b32 v254, v40
    v_exp_f32 v173, v141
    ds_write_b32 v14, v41
    v_exp_f32 v174, v142
    ds_read_b128 v[212:215], v233
    v_exp_f32 v175, v143
    v_exp_f32 v176, v144
    s_cmp_lt_i32 s51, s88
    s_waitcnt vmcnt(5)
    s_cbranch_scc1 Lw4
    s_waitcnt vmcnt(0)
Lw4:
    ds_read_b128 v[192:195], v228 offset:0
    v_exp_f32 v177, v145
    v_mfma_f32_32x32x16_bf16 v[160:175], v[224:227], v[224:227], v[160:175]
    v_exp_f32 v178, v146
    ds_read_b128 v[196:199], v229 offset:0
    v_exp_f32 v179, v147
    v_exp_f32 v180, v148
    ds_read_b128 v[200:203], v230 offset:0
    v_exp_f32 v181, v149
    v_exp_f32 v182, v150
    ds_read_b128 v[204:207], v231 offset:0
    v_exp_f32 v183, v151
    v_exp_f32 v184, v152
    ds_read_b128 v[208:211], v232 offset:0
    v_exp_f32 v185, v153
    v_exp_f32 v186, v154
    ds_read_b32 v252, v250 offset:384
    v_exp_f32 v187, v155
    ds_read_b32 v253, v251 offset:768
    v_exp_f32 v188, v156
    ds_read_u16 v240, v248 offset:256
    v_exp_f32 v189, v157
    ds_read_u16 v242, v248 offset:272
    v_exp_f32 v190, v158
    ds_read_u16 v244, v248 offset:288
    v_exp_f32 v191, v159
    ds_read_u16 v246, v248 offset:304
    v_rcp_f32 v160, v160
    ds_read_b32 v10, v249 offset:512
    v_rcp_f32 v161, v161
    v_mfma_f32_32x32x16_bf16 v[176:191], v[224:227], v[224:227], v[176:191]
    v_rcp_f32 v162, v162
    v_rcp_f32 v163, v163
    v_rcp_f32 v164, v164
    s_waitcnt lgkmcnt(0)
    v_rcp_f32 v165, v165
    s_cmp_lt_i32 s51, s86
    s_cbranch_scc0 Lnd5
    v_and_or_b32 v11, v10, s89, v238
    s_add_u32 m0, s52, 4096
    s_nop 0
    buffer_load_dwordx4 v11, s[8:11], 0 offen lds
    s_add_u32 m0, s52, 0
    s_nop 0
    buffer_load_dwordx4 v[240:241], s[36:39], 0 idxen offen lds
    s_add_u32 m0, s52, 1024
    s_nop 0
    buffer_load_dwordx4 v[242:243], s[36:39], 0 idxen offen lds
    s_add_u32 m0, s52, 2048
    s_nop 0
    buffer_load_dwordx4 v[244:245], s[36:39], 0 idxen offen lds
    s_add_u32 m0, s52, 3072
    s_nop 0
    buffer_load_dwordx4 v[246:247], s[36:39], 0 idxen offen lds
Lnd5:
    v_mfma_f32_32x32x16_bf16 v[96:111], v[192:195], v[16:19], 0
    v_rcp_f32 v166, v166
    v_rcp_f32 v167, v167
    v_rcp_f32 v168, v168
    v_mfma_f32_32x32x16_bf16 v[96:111], v[196:199], v[20:23], v[96:111]
    v_rcp_f32 v169, v169
    v_rcp_f32 v170, v170
    v_rcp_f32 v171, v171
    v_mfma_f32_32x32x16_bf16 v[96:111], v[208:211], v[24:27], v[96:111]
    v_rcp_f32 v172, v172
    v_rcp_f32 v173, v173
    v_rcp_f32 v174, v174
    v_mfma_f32_32x32x16_bf16 v[96:111], v[212:215], v[32:35], v[96:111]
    v_rcp_f32 v175, v175
    v_rcp_f32 v176, v176
    v_rcp_f32 v177, v177
    v_mfma_f32_32x32x16_bf16 v[112:127], v[200:203], v[16:19], 0
    v_rcp_f32 v178, v178
    v_rcp_f32 v179, v179
    v_rcp_f32 v180, v180
    v_mfma_f32_32x32x16_bf16 v[112:127], v[204:207], v[20:23], v[112:127]
    v_rcp_f32 v181, v181
    v_rcp_f32 v182, v182
    v_rcp_f32 v183, v183
    v_mfma_f32_32x32x16_bf16 v[112:127], v[208:211], v[28:31], v[112:127]
    v_rcp_f32 v184, v184
    v_rcp_f32 v185, v185
    v_rcp_f32 v186, v186
    v_mfma_f32_32x32x16_bf16 v[112:127], v[212:215], v[36:39], v[112:127]
    v_rcp_f32 v187, v187
    v_rcp_f32 v188, v188
    v_rcp_f32 v189, v189
    v_rcp_f32 v190, v190
    v_rcp_f32 v191, v191
    v_pk_mul_f32 v[160:161], v[160:161], v[128:129]
    v_pk_mul_f32 v[162:163], v[162:163], v[130:131]
    v_pk_mul_f32 v[164:165], v[164:165], v[132:133]
    v_pk_mul_f32 v[166:167], v[166:167], v[134:135]
    v_pk_mul_f32 v[168:169], v[168:169], v[136:137]
    v_pk_mul_f32 v[170:171], v[170:171], v[138:139]
    v_pk_mul_f32 v[172:173], v[172:173], v[140:141]
    v_pk_mul_f32 v[174:175], v[174:175], v[142:143]
    v_pk_mul_f32 v[176:177], v[176:177], v[144:145]
    v_pk_mul_f32 v[178:179], v[178:179], v[146:147]
    v_pk_mul_f32 v[180:181], v[180:181], v[148:149]
    v_pk_mul_f32 v[182:183], v[182:183], v[150:151]
    v_pk_mul_f32 v[184:185], v[184:185], v[152:153]
    v_pk_mul_f32 v[186:187], v[186:187], v[154:155]
    v_pk_mul_f32 v[188:189], v[188:189], v[156:157]
    v_pk_mul_f32 v[190:191], v[190:191], v[158:159]
    v_cvt_pk_bf16_f32 v128, v160, v161
    v_cvt_pk_bf16_f32 v129, v162, v163
    v_cvt_pk_bf16_f32 v130, v164, v165
    v_cvt_pk_bf16_f32 v131, v166, v167
    v_cvt_pk_bf16_f32 v132, v168, v169
    v_cvt_pk_bf16_f32 v133, v170, v171
    v_mfma_f32_32x32x16_bf16 v[64:79], v[128:131], v[216:219], v[64:79]
    v_cvt_pk_bf16_f32 v134, v172, v173
    v_cvt_pk_bf16_f32 v135, v174, v175
    v_cvt_pk_bf16_f32 v136, v176, v177
    v_cvt_pk_bf16_f32 v137, v178, v179
    v_mfma_f32_32x32x16_bf16 v[64:79], v[132:135], v[220:223], v[64:79]
    v_cvt_pk_bf16_f32 v138, v180, v181
    v_cvt_pk_bf16_f32 v139, v182, v183
    v_cvt_pk_bf16_f32 v140, v184, v185
    v_cvt_pk_bf16_f32 v141, v186, v187
    v_mfma_f32_32x32x16_bf16 v[80:95], v[136:139], v[216:219], v[80:95]
    v_cvt_pk_bf16_f32 v142, v188, v189
    v_cvt_pk_bf16_f32 v143, v190, v191
    s_nop 1
    v_mfma_f32_32x32x16_bf16 v[80:95], v[140:143], v[220:223], v[80:95]
    s_add_u32 s51, s51, 1
    v_add_u32 v248, 128, v248
    v_add_u32 v249, 256, v249
    v_add_u32 v250, 256, v250
    v_add_u32 v251, 512, v251
    s_branch L2_s0
L2_l0:
    s_cmp_lt_u32 s47, 250
    s_cbranch_scc1 L2_l0n
    v_lshlrev_b32 v10, 4, v1
    v_add_u32 v9, 2048, v10
    buffer_load_dwordx4 v[16:19], v9, s[24:27], 0 offen
    v_add_u32 v9, 3072, v10
    buffer_load_dwordx4 v[20:23], v9, s[24:27], 0 offen
    v_add_u32 v9, 4096, v10
    buffer_load_dwordx4 v[24:27], v9, s[24:27], 0 offen
    v_add_u32 v9, 5120, v10
    buffer_load_dwordx4 v[28:31], v9, s[24:27], 0 offen
    v_add_u32 v9, 6144, v10
    buffer_load_dwordx4 v[32:35], v9, s[24:27], 0 offen
    v_add_u32 v9, 7168, v10
    buffer_load_dwordx4 v[36:39], v9, s[24:27], 0 offen
    v_add_u32 v9, 8192, v10
    buffer_load_dwordx4 v[40:43], v9, s[24:27], 0 offen
    v_add_u32 v9, 9216, v10
    buffer_load_dwordx4 v[44:47], v9, s[24:27], 0 offen
    v_add_u32 v9, 10240, v10
    buffer_load_dwordx4 v[128:131], v9, s[24:27], 0 offen
    v_add_u32 v9, 11264, v10
    buffer_load_dwordx4 v[132:135], v9, s[24:27], 0 offen
    v_add_u32 v9, 12288, v10
    buffer_load_dwordx4 v[136:139], v9, s[24:27], 0 offen
    v_add_u32 v9, 13312, v10
    buffer_load_dwordx4 v[140:143], v9, s[24:27], 0 offen
    v_add_u32 v9, 14336, v10
    buffer_load_dwordx4 v[144:147], v9, s[24:27], 0 offen
    v_add_u32 v9, 15360, v10
    buffer_load_dwordx4 v[148:151], v9, s[24:27], 0 offen
    v_add_u32 v9, 16384, v10
    buffer_load_dwordx4 v[152:155], v9, s[24:27], 0 offen
    v_add_u32 v9, 17408, v10
    buffer_load_dwordx4 v[156:159], v9, s[24:27], 0 offen
    v_lshrrev_b32 v9, 3, v1
    v_lshlrev_b32 v9, 3, v9
    v_add_u32 v3, s101, v9
    v_add_u32 v9, s53, v9
    v_cmp_gt_u32 vcc, 49, v3
    v_mov_b32 v4, -1
    v_and_b32 v241, 7, v1
    v_lshlrev_b32 v241, 4, v241
    v_cndmask_b32 v240, v4, v9, vcc
    v_bfe_u32 v9, v1, 1, 3
    v_lshlrev_b32 v9, 3, v9
    v_add_u32 v3, s101, v9
    v_add_u32 v9, s53, v9
    v_bfe_u32 v5, v1, 4, 1
    v_and_b32 v8, 1, v1
    v_lshl_add_u32 v5, v5, 1, v8
    v_cmp_gt_u32 vcc, 49, v3
    v_subrev_u32 v5, 1, v5
    v_cmp_gt_u32 s[56:57], 3, v5
    v_mul_u32_u24 v9, 6, v9
    s_and_b64 vcc, vcc, s[56:57]
    v_cmp_gt_u32 s[56:57], 32, v1
    v_lshl_add_u32 v9, v5, 1, v9
    v_mov_b32 v4, 0x7fffff00
    s_and_b64 vcc, vcc, s[56:57]
    v_cndmask_b32 v10, v4, v9, vcc
    buffer_load_ushort v11, v10, s[20:23], 0 offen
    s_waitcnt lgkmcnt(0)
    s_add_u32 s84, s84, s85
    s_bitcmp1_b32 s84, 17
    s_cbranch_scc1 Lp6h
    s_bitcmp1_b32 s84, 16
    s_cbranch_scc1 Lp6a
    s_setprio 3
    s_branch Lp6z
Lp6a:
    s_setprio 2
    s_branch Lp6z
Lp6h:
    s_bitcmp1_b32 s84, 16
    s_cbranch_scc1 Lp6b
    s_setprio 1
    s_branch Lp6z
Lp6b:
    s_setprio 0
Lp6z:
    v_exp_f32 v160, v96
    ds_read_b64_tr_b16 v[216:217], v235 offset:0
    v_exp_f32 v161, v97
    v_exp_f32 v162, v98
    ds_read_b64_tr_b16 v[218:219], v15 offset:0
    v_exp_f32 v163, v99
    v_exp_f32 v164, v100
    ds_read_b64_tr_b16 v[220:221], v235 offset:1024
    v_exp_f32 v165, v101
    v_exp_f32 v166, v102
    ds_read_b64_tr_b16 v[222:223], v15 offset:1024
    v_exp_f32 v167, v103
    v_exp_f32 v168, v104
    ds_write_b32 v254, v225
    v_exp_f32 v169, v105
    v_exp_f32 v170, v106
    v_exp_f32 v171, v107
    v_exp_f32 v172, v108
    s_waitcnt lgkmcnt(0)
    s_lshl_b32 s62, s3, 11
    s_add_u32 s62, s62, 50432
    s_mov_b32 m0, s62
    s_nop 0
    buffer_load_dwordx4 v[240:241], s[4:7], 0 idxen offen lds
    v_exp_f32 v173, v109
    v_exp_f32 v174, v110
    v_exp_f32 v175, v111
    v_exp_f32 v176, v112
    v_exp_f32 v177, v113
    v_mfma_f32_32x32x16_bf16 v[160:175], v[224:227], v[224:227], v[160:175]
    v_exp_f32 v178, v114
    v_exp_f32 v179, v115
    v_exp_f32 v180, v116
    v_exp_f32 v181, v117
    v_exp_f32 v182, v118
    v_exp_f32 v183, v119
    v_exp_f32 v184, v120
    v_exp_f32 v185, v121
    v_exp_f32 v186, v122
    v_exp_f32 v187, v123
    v_exp_f32 v188, v124
    v_exp_f32 v189, v125
    v_exp_f32 v190, v126
    v_exp_f32 v191, v127
    v_rcp_f32 v160, v160
    v_rcp_f32 v161, v161
    v_mfma_f32_32x32x16_bf16 v[176:191], v[224:227], v[224:227], v[176:191]
    v_rcp_f32 v162, v162
    v_rcp_f32 v163, v163
    v_rcp_f32 v164, v164
    v_rcp_f32 v165, v165
    v_rcp_f32 v166, v166
    v_rcp_f32 v167, v167
    v_rcp_f32 v168, v168
    v_rcp_f32 v169, v169
    v_rcp_f32 v170, v170
    v_rcp_f32 v171, v171
    v_rcp_f32 v172, v172
    v_rcp_f32 v173, v173
    v_rcp_f32 v174, v174
    v_rcp_f32 v175, v175
    v_rcp_f32 v176, v176
    v_rcp_f32 v177, v177
    v_rcp_f32 v178, v178
    v_rcp_f32 v179, v179
    v_rcp_f32 v180, v180
    v_rcp_f32 v181, v181
    v_rcp_f32 v182, v182
    v_rcp_f32 v183, v183
    v_rcp_f32 v184, v184
    v_rcp_f32 v185, v185
    v_rcp_f32 v186, v186
    v_rcp_f32 v187, v187
    v_rcp_f32 v188, v188
    v_rcp_f32 v189, v189
    v_rcp_f32 v190, v190
    v_rcp_f32 v191, v191
    v_pk_mul_f32 v[160:161], v[160:161], v[96:97]
    v_pk_mul_f32 v[162:163], v[162:163], v[98:99]
    v_pk_mul_f32 v[164:165], v[164:165], v[100:101]
    v_pk_mul_f32 v[166:167], v[166:167], v[102:103]
    v_pk_mul_f32 v[168:169], v[168:169], v[104:105]
    v_pk_mul_f32 v[170:171], v[170:171], v[106:107]
    v_pk_mul_f32 v[172:173], v[172:173], v[108:109]
    v_pk_mul_f32 v[174:175], v[174:175], v[110:111]
    v_pk_mul_f32 v[176:177], v[176:177], v[112:113]
    v_pk_mul_f32 v[178:179], v[178:179], v[114:115]
    v_pk_mul_f32 v[180:181], v[180:181], v[116:117]
    v_pk_mul_f32 v[182:183], v[182:183], v[118:119]
    v_pk_mul_f32 v[184:185], v[184:185], v[120:121]
    v_pk_mul_f32 v[186:187], v[186:187], v[122:123]
    v_pk_mul_f32 v[188:189], v[188:189], v[124:125]
    v_pk_mul_f32 v[190:191], v[190:191], v[126:127]
    v_cvt_pk_bf16_f32 v96, v160, v161
    v_cvt_pk_bf16_f32 v97, v162, v163
    v_cvt_pk_bf16_f32 v98, v164, v165
    v_cvt_pk_bf16_f32 v99, v166, v167
    v_cvt_pk_bf16_f32 v100, v168, v169
    v_cvt_pk_bf16_f32 v101, v170, v171
    v_mfma_f32_32x32x16_bf16 v[64:79], v[96:99], v[216:219], v[64:79]
    v_cvt_pk_bf16_f32 v102, v172, v173
    v_cvt_pk_bf16_f32 v103, v174, v175
    v_cvt_pk_bf16_f32 v104, v176, v177
    v_cvt_pk_bf16_f32 v105, v178, v179
    v_mfma_f32_32x32x16_bf16 v[64:79], v[100:103], v[220:223], v[64:79]
    v_cvt_pk_bf16_f32 v106, v180, v181
    v_cvt_pk_bf16_f32 v107, v182, v183
    v_cvt_pk_bf16_f32 v108, v184, v185
    v_cvt_pk_bf16_f32 v109, v186, v187
    v_mfma_f32_32x32x16_bf16 v[80:95], v[104:107], v[216:219], v[80:95]
    v_cvt_pk_bf16_f32 v110, v188, v189
    v_cvt_pk_bf16_f32 v111, v190, v191
    s_nop 1
    v_mfma_f32_32x32x16_bf16 v[80:95], v[108:111], v[220:223], v[80:95]
    v_and_b32 v3, 31, v1
    v_lshrrev_b32 v4, 5, v1
    v_bfe_u32 v5, v1, 1, 3
    v_lshlrev_b32 v5, 7, v5
    v_lshl_add_u32 v5, v4, 4, v5
    v_add_u32 v5, s62, v5
    v_lshlrev_b32 v6, 7, v4
    v_add_u32 v6, 160512, v6
    v_lshlrev_b32 v7, 1, v3
    v_lshl_add_u32 v7, v4, 8, v7
    v_add_u32 v7, s62, v7
    s_mov_b32 s54, 3207688728
    s_mov_b32 s55, s54
    s_waitcnt vmcnt(0)
    ds_read_b128 v[48:51], v5 offset:0
    ds_read_b128 v[52:55], v5 offset:32
    ds_read_b128 v[56:59], v5 offset:64
    ds_read_b128 v[60:63], v5 offset:96
    ds_read_b128 v[192:195], v6 offset:0
    ds_read_b128 v[196:199], v6 offset:16
    ds_read_b128 v[200:203], v6 offset:32
    ds_read_b128 v[204:207], v6 offset:48
    ds_read_b128 v[208:211], v6 offset:64
    ds_read_b128 v[212:215], v6 offset:80
    ds_read_b128 v[228:231], v6 offset:96
    ds_read_b128 v[248:251], v6 offset:112
    v_pk_mul_f32 v[64:65], v[64:65], s[54:55]
    v_pk_mul_f32 v[66:67], v[66:67], s[54:55]
    v_pk_mul_f32 v[68:69], v[68:69], s[54:55]
    v_pk_mul_f32 v[70:71], v[70:71], s[54:55]
    v_pk_mul_f32 v[72:73], v[72:73], s[54:55]
    v_pk_mul_f32 v[74:75], v[74:75], s[54:55]
    v_pk_mul_f32 v[76:77], v[76:77], s[54:55]
    v_pk_mul_f32 v[78:79], v[78:79], s[54:55]
    v_pk_mul_f32 v[80:81], v[80:81], s[54:55]
    v_pk_mul_f32 v[82:83], v[82:83], s[54:55]
    v_pk_mul_f32 v[84:85], v[84:85], s[54:55]
    v_pk_mul_f32 v[86:87], v[86:87], s[54:55]
    v_pk_mul_f32 v[88:89], v[88:89], s[54:55]
    v_pk_mul_f32 v[90:91], v[90:91], s[54:55]
    v_pk_mul_f32 v[92:93], v[92:93], s[54:55]
    v_pk_mul_f32 v[94:95], v[94:95], s[54:55]
    s_waitcnt lgkmcnt(8)
    v_mfma_f32_32x32x16_bf16 v[96:111], v[48:51], v[16:19], 0
    v_mfma_f32_32x32x16_bf16 v[96:111], v[52:55], v[24:27], v[96:111]
    v_mfma_f32_32x32x16_bf16 v[96:111], v[56:59], v[32:35], v[96:111]
    v_mfma_f32_32x32x16_bf16 v[96:111], v[60:63], v[40:43], v[96:111]
    v_cvt_pk_bf16_f32 v160, v64, v65
    v_cvt_pk_bf16_f32 v161, v66, v67
    v_cvt_pk_bf16_f32 v162, v68, v69
    v_cvt_pk_bf16_f32 v163, v70, v71
    v_cvt_pk_bf16_f32 v164, v72, v73
    v_cvt_pk_bf16_f32 v165, v74, v75
    v_cvt_pk_bf16_f32 v166, v76, v77
    v_cvt_pk_bf16_f32 v167, v78, v79
    v_cvt_pk_bf16_f32 v168, v80, v81
    v_cvt_pk_bf16_f32 v169, v82, v83
    v_cvt_pk_bf16_f32 v170, v84, v85
    v_cvt_pk_bf16_f32 v171, v86, v87
    v_cvt_pk_bf16_f32 v172, v88, v89
    v_cvt_pk_bf16_f32 v173, v90, v91
    v_cvt_pk_bf16_f32 v174, v92, v93
    v_cvt_pk_bf16_f32 v175, v94, v95
    v_mfma_f32_32x32x16_bf16 v[112:127], v[48:51], v[20:23], 0
    v_mfma_f32_32x32x16_bf16 v[112:127], v[52:55], v[28:31], v[112:127]
    v_mfma_f32_32x32x16_bf16 v[112:127], v[56:59], v[36:39], v[112:127]
    v_mfma_f32_32x32x16_bf16 v[112:127], v[60:63], v[44:47], v[112:127]
    ds_read_u16 v232, v7 offset:0
    ds_read_u16 v233, v7 offset:128
    ds_read_u16 v234, v7 offset:512
    ds_read_u16 v236, v7 offset:640
    ds_read_u16 v237, v7 offset:64
    ds_read_u16 v238, v7 offset:192
    ds_read_u16 v252, v7 offset:576
    ds_read_u16 v253, v7 offset:704
    v_mfma_f32_32x32x16_bf16 v[96:111], v[160:163], v[128:131], v[96:111]
    v_mfma_f32_32x32x16_bf16 v[96:111], v[164:167], v[136:139], v[96:111]
    v_mfma_f32_32x32x16_bf16 v[96:111], v[168:171], v[144:147], v[96:111]
    v_mfma_f32_32x32x16_bf16 v[96:111], v[172:175], v[152:155], v[96:111]
    s_waitcnt lgkmcnt(8)
    v_mul_f32 v184, v64, v192
    v_mul_f32 v185, v65, v193
    v_fmac_f32 v184, v66, v194
    v_fmac_f32 v185, v67, v195
    v_fmac_f32 v184, v68, v196
    v_fmac_f32 v185, v69, v197
    v_fmac_f32 v184, v70, v198
    v_fmac_f32 v185, v71, v199
    v_fmac_f32 v184, v72, v200
    v_fmac_f32 v185, v73, v201
    v_fmac_f32 v184, v74, v202
    v_fmac_f32 v185, v75, v203
    v_fmac_f32 v184, v76, v204
    v_fmac_f32 v185, v77, v205
    v_fmac_f32 v184, v78, v206
    v_fmac_f32 v185, v79, v207
    v_fmac_f32 v184, v80, v208
    v_fmac_f32 v185, v81, v209
    v_fmac_f32 v184, v82, v210
    v_fmac_f32 v185, v83, v211
    v_fmac_f32 v184, v84, v212
    v_fmac_f32 v185, v85, v213
    v_fmac_f32 v184, v86, v214
    v_fmac_f32 v185, v87, v215
    v_fmac_f32 v184, v88, v228
    v_fmac_f32 v185, v89, v229
    v_fmac_f32 v184, v90, v230
    v_fmac_f32 v185, v91, v231
    v_fmac_f32 v184, v92, v248
    v_fmac_f32 v185, v93, v249
    v_fmac_f32 v184, v94, v250
    v_fmac_f32 v185, v95, v251
    v_add_f32 v184, v184, v185
    v_mov_b32 v185, v184
    v_mfma_f32_32x32x16_bf16 v[112:127], v[160:163], v[132:135], v[112:127]
    v_mfma_f32_32x32x16_bf16 v[112:127], v[164:167], v[140:143], v[112:127]
    v_mfma_f32_32x32x16_bf16 v[112:127], v[168:171], v[148:151], v[112:127]
    v_mfma_f32_32x32x16_bf16 v[112:127], v[172:175], v[156:159], v[112:127]
    v_permlane32_swap_b32 v184, v185
    v_lshlrev_b32 v11, 16, v11
    v_add_f32 v184, v184, v185
    v_add_f32 v11, v11, v184
    v_cvt_pk_bf16_f32 v11, v11, v11
    buffer_store_short v11, v10, s[32:35], 0 offen
    s_mov_b32 s54, 3216550459
    v_mul_f32 v176, s54, v96
    v_mul_f32 v177, s54, v98
    v_mul_f32 v178, s54, v100
    v_mul_f32 v179, s54, v102
    s_nop 0
    v_mul_f32 v180, s54, v112
    v_mul_f32 v181, s54, v114
    v_mul_f32 v182, s54, v116
    v_mul_f32 v183, s54, v118
    v_exp_f32 v176, v176
    v_exp_f32 v177, v177
    v_exp_f32 v178, v178
    v_exp_f32 v179, v179
    v_exp_f32 v180, v180
    v_exp_f32 v181, v181
    v_exp_f32 v182, v182
    v_exp_f32 v183, v183
    v_add_f32 v176, 1.0, v176
    v_add_f32 v177, 1.0, v177
    v_add_f32 v178, 1.0, v178
    v_add_f32 v179, 1.0, v179
    v_add_f32 v180, 1.0, v180
    v_add_f32 v181, 1.0, v181
    v_add_f32 v182, 1.0, v182
    v_add_f32 v183, 1.0, v183
    v_rcp_f32 v176, v176
    v_rcp_f32 v177, v177
    v_rcp_f32 v178, v178
    v_rcp_f32 v179, v179
    v_rcp_f32 v180, v180
    v_rcp_f32 v181, v181
    v_rcp_f32 v182, v182
    v_rcp_f32 v183, v183
    s_waitcnt lgkmcnt(0)
    v_lshlrev_b32 v232, 16, v232
    v_fma_f32 v176, v96, v176, v232
    v_cvt_pk_bf16_f32 v176, v176, v176
    v_lshlrev_b32 v233, 16, v233
    v_fma_f32 v177, v98, v177, v233
    v_cvt_pk_bf16_f32 v177, v177, v177
    v_lshlrev_b32 v234, 16, v234
    v_fma_f32 v178, v100, v178, v234
    v_cvt_pk_bf16_f32 v178, v178, v178
    v_lshlrev_b32 v236, 16, v236
    v_fma_f32 v179, v102, v179, v236
    v_cvt_pk_bf16_f32 v179, v179, v179
    v_lshlrev_b32 v237, 16, v237
    v_fma_f32 v180, v112, v180, v237
    v_cvt_pk_bf16_f32 v180, v180, v180
    v_lshlrev_b32 v238, 16, v238
    v_fma_f32 v181, v114, v181, v238
    v_cvt_pk_bf16_f32 v181, v181, v181
    v_lshlrev_b32 v252, 16, v252
    v_fma_f32 v182, v116, v182, v252
    v_cvt_pk_bf16_f32 v182, v182, v182
    v_lshlrev_b32 v253, 16, v253
    v_fma_f32 v183, v118, v183, v253
    v_cvt_pk_bf16_f32 v183, v183, v183
    ds_write_b16 v7, v176 offset:1024
    ds_write_b16 v7, v177 offset:1152
    ds_write_b16 v7, v178 offset:1536
    ds_write_b16 v7, v179 offset:1664
    ds_write_b16 v7, v180 offset:1088
    ds_write_b16 v7, v181 offset:1216
    ds_write_b16 v7, v182 offset:1600
    ds_write_b16 v7, v183 offset:1728
    v_lshlrev_b32 v6, 4, v1
    v_add_u32 v6, s62, v6
    ds_read_b128 v[48:51], v6 offset:1024
    s_waitcnt lgkmcnt(0)
    buffer_store_dwordx4 v[48:51], v[240:241], s[28:31], 0 idxen offen
    s_endpgm
L2_l0n:
    s_waitcnt lgkmcnt(0)
    s_add_u32 s84, s84, s85
    s_bitcmp1_b32 s84, 17
    s_cbranch_scc1 Lp7h
    s_bitcmp1_b32 s84, 16
    s_cbranch_scc1 Lp7a
    s_setprio 3
    s_branch Lp7z
Lp7a:
    s_setprio 2
    s_branch Lp7z
Lp7h:
    s_bitcmp1_b32 s84, 16
    s_cbranch_scc1 Lp7b
    s_setprio 1
    s_branch Lp7z
Lp7b:
    s_setprio 0
Lp7z:
    v_exp_f32 v160, v96
    ds_read_b64_tr_b16 v[216:217], v235 offset:0
    v_exp_f32 v161, v97
    v_exp_f32 v162, v98
    ds_read_b64_tr_b16 v[218:219], v15 offset:0
    v_exp_f32 v163, v99
    v_exp_f32 v164, v100
    ds_read_b64_tr_b16 v[220:221], v235 offset:1024
    v_exp_f32 v165, v101
    v_exp_f32 v166, v102
    ds_read_b64_tr_b16 v[222:223], v15 offset:1024
    v_exp_f32 v167, v103
    v_exp_f32 v168, v104
    ds_write_b32 v254, v225
    v_exp_f32 v169, v105
    v_exp_f32 v170, v106
    v_exp_f32 v171, v107
    v_exp_f32 v172, v108
    v_exp_f32 v173, v109
    v_exp_f32 v174, v110
    v_exp_f32 v175, v111
    v_exp_f32 v176, v112
    v_exp_f32 v177, v113
    v_mfma_f32_32x32x16_bf16 v[160:175], v[224:227], v[224:227], v[160:175]
    v_exp_f32 v178, v114
    v_exp_f32 v179, v115
    v_exp_f32 v180, v116
    v_exp_f32 v181, v117
    v_exp_f32 v182, v118
    v_exp_f32 v183, v119
    v_exp_f32 v184, v120
    v_exp_f32 v185, v121
    v_exp_f32 v186, v122
    v_exp_f32 v187, v123
    v_exp_f32 v188, v124
    v_exp_f32 v189, v125
    v_exp_f32 v190, v126
    v_exp_f32 v191, v127
    v_rcp_f32 v160, v160
    v_rcp_f32 v161, v161
    v_mfma_f32_32x32x16_bf16 v[176:191], v[224:227], v[224:227], v[176:191]
    v_rcp_f32 v162, v162
    v_rcp_f32 v163, v163
    v_rcp_f32 v164, v164
    v_rcp_f32 v165, v165
    v_rcp_f32 v166, v166
    v_rcp_f32 v167, v167
    v_rcp_f32 v168, v168
    v_rcp_f32 v169, v169
    v_rcp_f32 v170, v170
    v_rcp_f32 v171, v171
    v_rcp_f32 v172, v172
    v_rcp_f32 v173, v173
    v_rcp_f32 v174, v174
    v_rcp_f32 v175, v175
    v_rcp_f32 v176, v176
    v_rcp_f32 v177, v177
    v_rcp_f32 v178, v178
    v_rcp_f32 v179, v179
    v_rcp_f32 v180, v180
    v_rcp_f32 v181, v181
    v_rcp_f32 v182, v182
    v_rcp_f32 v183, v183
    v_rcp_f32 v184, v184
    v_rcp_f32 v185, v185
    v_rcp_f32 v186, v186
    v_rcp_f32 v187, v187
    v_rcp_f32 v188, v188
    v_rcp_f32 v189, v189
    v_rcp_f32 v190, v190
    v_rcp_f32 v191, v191
    v_pk_mul_f32 v[160:161], v[160:161], v[96:97]
    v_pk_mul_f32 v[162:163], v[162:163], v[98:99]
    v_pk_mul_f32 v[164:165], v[164:165], v[100:101]
    v_pk_mul_f32 v[166:167], v[166:167], v[102:103]
    v_pk_mul_f32 v[168:169], v[168:169], v[104:105]
    v_pk_mul_f32 v[170:171], v[170:171], v[106:107]
    v_pk_mul_f32 v[172:173], v[172:173], v[108:109]
    v_pk_mul_f32 v[174:175], v[174:175], v[110:111]
    v_pk_mul_f32 v[176:177], v[176:177], v[112:113]
    v_pk_mul_f32 v[178:179], v[178:179], v[114:115]
    v_pk_mul_f32 v[180:181], v[180:181], v[116:117]
    v_pk_mul_f32 v[182:183], v[182:183], v[118:119]
    v_pk_mul_f32 v[184:185], v[184:185], v[120:121]
    v_pk_mul_f32 v[186:187], v[186:187], v[122:123]
    v_pk_mul_f32 v[188:189], v[188:189], v[124:125]
    v_pk_mul_f32 v[190:191], v[190:191], v[126:127]
    v_cvt_pk_bf16_f32 v96, v160, v161
    v_cvt_pk_bf16_f32 v97, v162, v163
    v_cvt_pk_bf16_f32 v98, v164, v165
    v_cvt_pk_bf16_f32 v99, v166, v167
    v_cvt_pk_bf16_f32 v100, v168, v169
    v_cvt_pk_bf16_f32 v101, v170, v171
    v_mfma_f32_32x32x16_bf16 v[64:79], v[96:99], v[216:219], v[64:79]
    v_cvt_pk_bf16_f32 v102, v172, v173
    v_cvt_pk_bf16_f32 v103, v174, v175
    v_cvt_pk_bf16_f32 v104, v176, v177
    v_cvt_pk_bf16_f32 v105, v178, v179
    v_mfma_f32_32x32x16_bf16 v[64:79], v[100:103], v[220:223], v[64:79]
    v_cvt_pk_bf16_f32 v106, v180, v181
    v_cvt_pk_bf16_f32 v107, v182, v183
    v_cvt_pk_bf16_f32 v108, v184, v185
    v_cvt_pk_bf16_f32 v109, v186, v187
    v_mfma_f32_32x32x16_bf16 v[80:95], v[104:107], v[216:219], v[80:95]
    v_cvt_pk_bf16_f32 v110, v188, v189
    v_cvt_pk_bf16_f32 v111, v190, v191
    s_nop 1
    v_mfma_f32_32x32x16_bf16 v[80:95], v[108:111], v[220:223], v[80:95]
    s_branch L2_nextbatch
L2_l1:
    s_cmp_lt_u32 s47, 250
    s_cbranch_scc1 L2_l1n
    v_lshlrev_b32 v10, 4, v1
    v_add_u32 v9, 2048, v10
    buffer_load_dwordx4 v[16:19], v9, s[24:27], 0 offen
    v_add_u32 v9, 3072, v10
    buffer_load_dwordx4 v[20:23], v9, s[24:27], 0 offen
    v_add_u32 v9, 4096, v10
    buffer_load_dwordx4 v[24:27], v9, s[24:27], 0 offen
    v_add_u32 v9, 5120, v10
    buffer_load_dwordx4 v[28:31], v9, s[24:27], 0 offen
    v_add_u32 v9, 6144, v10
    buffer_load_dwordx4 v[32:35], v9, s[24:27], 0 offen
    v_add_u32 v9, 7168, v10
    buffer_load_dwordx4 v[36:39], v9, s[24:27], 0 offen
    v_add_u32 v9, 8192, v10
    buffer_load_dwordx4 v[40:43], v9, s[24:27], 0 offen
    v_add_u32 v9, 9216, v10
    buffer_load_dwordx4 v[44:47], v9, s[24:27], 0 offen
    v_add_u32 v9, 10240, v10
    buffer_load_dwordx4 v[96:99], v9, s[24:27], 0 offen
    v_add_u32 v9, 11264, v10
    buffer_load_dwordx4 v[100:103], v9, s[24:27], 0 offen
    v_add_u32 v9, 12288, v10
    buffer_load_dwordx4 v[104:107], v9, s[24:27], 0 offen
    v_add_u32 v9, 13312, v10
    buffer_load_dwordx4 v[108:111], v9, s[24:27], 0 offen
    v_add_u32 v9, 14336, v10
    buffer_load_dwordx4 v[112:115], v9, s[24:27], 0 offen
    v_add_u32 v9, 15360, v10
    buffer_load_dwordx4 v[116:119], v9, s[24:27], 0 offen
    v_add_u32 v9, 16384, v10
    buffer_load_dwordx4 v[120:123], v9, s[24:27], 0 offen
    v_add_u32 v9, 17408, v10
    buffer_load_dwordx4 v[124:127], v9, s[24:27], 0 offen
    v_lshrrev_b32 v9, 3, v1
    v_lshlrev_b32 v9, 3, v9
    v_add_u32 v3, s101, v9
    v_add_u32 v9, s53, v9
    v_cmp_gt_u32 vcc, 49, v3
    v_mov_b32 v4, -1
    v_and_b32 v241, 7, v1
    v_lshlrev_b32 v241, 4, v241
    v_cndmask_b32 v240, v4, v9, vcc
    v_bfe_u32 v9, v1, 1, 3
    v_lshlrev_b32 v9, 3, v9
    v_add_u32 v3, s101, v9
    v_add_u32 v9, s53, v9
    v_bfe_u32 v5, v1, 4, 1
    v_and_b32 v8, 1, v1
    v_lshl_add_u32 v5, v5, 1, v8
    v_cmp_gt_u32 vcc, 49, v3
    v_subrev_u32 v5, 1, v5
    v_cmp_gt_u32 s[56:57], 3, v5
    v_mul_u32_u24 v9, 6, v9
    s_and_b64 vcc, vcc, s[56:57]
    v_cmp_gt_u32 s[56:57], 32, v1
    v_lshl_add_u32 v9, v5, 1, v9
    v_mov_b32 v4, 0x7fffff00
    s_and_b64 vcc, vcc, s[56:57]
    v_cndmask_b32 v10, v4, v9, vcc
    buffer_load_ushort v11, v10, s[20:23], 0 offen
    s_waitcnt lgkmcnt(0)
    v_exp_f32 v160, v128
    ds_read_b64_tr_b16 v[216:217], v235 offset:0
    v_exp_f32 v161, v129
    v_exp_f32 v162, v130
    ds_read_b64_tr_b16 v[218:219], v15 offset:0
    v_exp_f32 v163, v131
    v_exp_f32 v164, v132
    ds_read_b64_tr_b16 v[220:221], v235 offset:1024
    v_exp_f32 v165, v133
    v_exp_f32 v166, v134
    ds_read_b64_tr_b16 v[222:223], v15 offset:1024
    v_exp_f32 v167, v135
    v_exp_f32 v168, v136
    ds_write_b32 v254, v225
    v_exp_f32 v169, v137
    v_exp_f32 v170, v138
    v_exp_f32 v171, v139
    v_exp_f32 v172, v140
    s_waitcnt lgkmcnt(0)
    s_lshl_b32 s62, s3, 11
    s_add_u32 s62, s62, 50432
    s_mov_b32 m0, s62
    s_nop 0
    buffer_load_dwordx4 v[240:241], s[4:7], 0 idxen offen lds
    v_exp_f32 v173, v141
    v_exp_f32 v174, v142
    v_exp_f32 v175, v143
    v_exp_f32 v176, v144
    v_exp_f32 v177, v145
    v_mfma_f32_32x32x16_bf16 v[160:175], v[224:227], v[224:227], v[160:175]
    v_exp_f32 v178, v146
    v_exp_f32 v179, v147
    v_exp_f32 v180, v148
    v_exp_f32 v181, v149
    v_exp_f32 v182, v150
    v_exp_f32 v183, v151
    v_exp_f32 v184, v152
    v_exp_f32 v185, v153
    v_exp_f32 v186, v154
    v_exp_f32 v187, v155
    v_exp_f32 v188, v156
    v_exp_f32 v189, v157
    v_exp_f32 v190, v158
    v_exp_f32 v191, v159
    v_rcp_f32 v160, v160
    v_rcp_f32 v161, v161
    v_mfma_f32_32x32x16_bf16 v[176:191], v[224:227], v[224:227], v[176:191]
    v_rcp_f32 v162, v162
    v_rcp_f32 v163, v163
    v_rcp_f32 v164, v164
    v_rcp_f32 v165, v165
    v_rcp_f32 v166, v166
    v_rcp_f32 v167, v167
    v_rcp_f32 v168, v168
    v_rcp_f32 v169, v169
    v_rcp_f32 v170, v170
    v_rcp_f32 v171, v171
    v_rcp_f32 v172, v172
    v_rcp_f32 v173, v173
    v_rcp_f32 v174, v174
    v_rcp_f32 v175, v175
    v_rcp_f32 v176, v176
    v_rcp_f32 v177, v177
    v_rcp_f32 v178, v178
    v_rcp_f32 v179, v179
    v_rcp_f32 v180, v180
    v_rcp_f32 v181, v181
    v_rcp_f32 v182, v182
    v_rcp_f32 v183, v183
    v_rcp_f32 v184, v184
    v_rcp_f32 v185, v185
    v_rcp_f32 v186, v186
    v_rcp_f32 v187, v187
    v_rcp_f32 v188, v188
    v_rcp_f32 v189, v189
    v_rcp_f32 v190, v190
    v_rcp_f32 v191, v191
    v_pk_mul_f32 v[160:161], v[160:161], v[128:129]
    v_pk_mul_f32 v[162:163], v[162:163], v[130:131]
    v_pk_mul_f32 v[164:165], v[164:165], v[132:133]
    v_pk_mul_f32 v[166:167], v[166:167], v[134:135]
    v_pk_mul_f32 v[168:169], v[168:169], v[136:137]
    v_pk_mul_f32 v[170:171], v[170:171], v[138:139]
    v_pk_mul_f32 v[172:173], v[172:173], v[140:141]
    v_pk_mul_f32 v[174:175], v[174:175], v[142:143]
    v_pk_mul_f32 v[176:177], v[176:177], v[144:145]
    v_pk_mul_f32 v[178:179], v[178:179], v[146:147]
    v_pk_mul_f32 v[180:181], v[180:181], v[148:149]
    v_pk_mul_f32 v[182:183], v[182:183], v[150:151]
    v_pk_mul_f32 v[184:185], v[184:185], v[152:153]
    v_pk_mul_f32 v[186:187], v[186:187], v[154:155]
    v_pk_mul_f32 v[188:189], v[188:189], v[156:157]
    v_pk_mul_f32 v[190:191], v[190:191], v[158:159]
    v_cvt_pk_bf16_f32 v128, v160, v161
    v_cvt_pk_bf16_f32 v129, v162, v163
    v_cvt_pk_bf16_f32 v130, v164, v165
    v_cvt_pk_bf16_f32 v131, v166, v167
    v_cvt_pk_bf16_f32 v132, v168, v169
    v_cvt_pk_bf16_f32 v133, v170, v171
    v_mfma_f32_32x32x16_bf16 v[64:79], v[128:131], v[216:219], v[64:79]
    v_cvt_pk_bf16_f32 v134, v172, v173
    v_cvt_pk_bf16_f32 v135, v174, v175
    v_cvt_pk_bf16_f32 v136, v176, v177
    v_cvt_pk_bf16_f32 v137, v178, v179
    v_mfma_f32_32x32x16_bf16 v[64:79], v[132:135], v[220:223], v[64:79]
    v_cvt_pk_bf16_f32 v138, v180, v181
    v_cvt_pk_bf16_f32 v139, v182, v183
    v_cvt_pk_bf16_f32 v140, v184, v185
    v_cvt_pk_bf16_f32 v141, v186, v187
    v_mfma_f32_32x32x16_bf16 v[80:95], v[136:139], v[216:219], v[80:95]
    v_cvt_pk_bf16_f32 v142, v188, v189
    v_cvt_pk_bf16_f32 v143, v190, v191
    s_nop 1
    v_mfma_f32_32x32x16_bf16 v[80:95], v[140:143], v[220:223], v[80:95]
    v_and_b32 v3, 31, v1
    v_lshrrev_b32 v4, 5, v1
    v_bfe_u32 v5, v1, 1, 3
    v_lshlrev_b32 v5, 7, v5
    v_lshl_add_u32 v5, v4, 4, v5
    v_add_u32 v5, s62, v5
    v_lshlrev_b32 v6, 7, v4
    v_add_u32 v6, 160512, v6
    v_lshlrev_b32 v7, 1, v3
    v_lshl_add_u32 v7, v4, 8, v7
    v_add_u32 v7, s62, v7
    s_mov_b32 s54, 3207688728
    s_mov_b32 s55, s54
    s_waitcnt vmcnt(0)
    ds_read_b128 v[48:51], v5 offset:0
    ds_read_b128 v[52:55], v5 offset:32
    ds_read_b128 v[56:59], v5 offset:64
    ds_read_b128 v[60:63], v5 offset:96
    ds_read_b128 v[192:195], v6 offset:0
    ds_read_b128 v[196:199], v6 offset:16
    ds_read_b128 v[200:203], v6 offset:32
    ds_read_b128 v[204:207], v6 offset:48
    ds_read_b128 v[208:211], v6 offset:64
    ds_read_b128 v[212:215], v6 offset:80
    ds_read_b128 v[228:231], v6 offset:96
    ds_read_b128 v[248:251], v6 offset:112
    v_pk_mul_f32 v[64:65], v[64:65], s[54:55]
    v_pk_mul_f32 v[66:67], v[66:67], s[54:55]
    v_pk_mul_f32 v[68:69], v[68:69], s[54:55]
    v_pk_mul_f32 v[70:71], v[70:71], s[54:55]
    v_pk_mul_f32 v[72:73], v[72:73], s[54:55]
    v_pk_mul_f32 v[74:75], v[74:75], s[54:55]
    v_pk_mul_f32 v[76:77], v[76:77], s[54:55]
    v_pk_mul_f32 v[78:79], v[78:79], s[54:55]
    v_pk_mul_f32 v[80:81], v[80:81], s[54:55]
    v_pk_mul_f32 v[82:83], v[82:83], s[54:55]
    v_pk_mul_f32 v[84:85], v[84:85], s[54:55]
    v_pk_mul_f32 v[86:87], v[86:87], s[54:55]
    v_pk_mul_f32 v[88:89], v[88:89], s[54:55]
    v_pk_mul_f32 v[90:91], v[90:91], s[54:55]
    v_pk_mul_f32 v[92:93], v[92:93], s[54:55]
    v_pk_mul_f32 v[94:95], v[94:95], s[54:55]
    s_waitcnt lgkmcnt(8)
    v_mfma_f32_32x32x16_bf16 v[128:143], v[48:51], v[16:19], 0
    v_mfma_f32_32x32x16_bf16 v[128:143], v[52:55], v[24:27], v[128:143]
    v_mfma_f32_32x32x16_bf16 v[128:143], v[56:59], v[32:35], v[128:143]
    v_mfma_f32_32x32x16_bf16 v[128:143], v[60:63], v[40:43], v[128:143]
    v_cvt_pk_bf16_f32 v160, v64, v65
    v_cvt_pk_bf16_f32 v161, v66, v67
    v_cvt_pk_bf16_f32 v162, v68, v69
    v_cvt_pk_bf16_f32 v163, v70, v71
    v_cvt_pk_bf16_f32 v164, v72, v73
    v_cvt_pk_bf16_f32 v165, v74, v75
    v_cvt_pk_bf16_f32 v166, v76, v77
    v_cvt_pk_bf16_f32 v167, v78, v79
    v_cvt_pk_bf16_f32 v168, v80, v81
    v_cvt_pk_bf16_f32 v169, v82, v83
    v_cvt_pk_bf16_f32 v170, v84, v85
    v_cvt_pk_bf16_f32 v171, v86, v87
    v_cvt_pk_bf16_f32 v172, v88, v89
    v_cvt_pk_bf16_f32 v173, v90, v91
    v_cvt_pk_bf16_f32 v174, v92, v93
    v_cvt_pk_bf16_f32 v175, v94, v95
    v_mfma_f32_32x32x16_bf16 v[144:159], v[48:51], v[20:23], 0
    v_mfma_f32_32x32x16_bf16 v[144:159], v[52:55], v[28:31], v[144:159]
    v_mfma_f32_32x32x16_bf16 v[144:159], v[56:59], v[36:39], v[144:159]
    v_mfma_f32_32x32x16_bf16 v[144:159], v[60:63], v[44:47], v[144:159]
    ds_read_u16 v232, v7 offset:0
    ds_read_u16 v233, v7 offset:128
    ds_read_u16 v234, v7 offset:512
    ds_read_u16 v236, v7 offset:640
    ds_read_u16 v237, v7 offset:64
    ds_read_u16 v238, v7 offset:192
    ds_read_u16 v252, v7 offset:576
    ds_read_u16 v253, v7 offset:704
    v_mfma_f32_32x32x16_bf16 v[128:143], v[160:163], v[96:99], v[128:143]
    v_mfma_f32_32x32x16_bf16 v[128:143], v[164:167], v[104:107], v[128:143]
    v_mfma_f32_32x32x16_bf16 v[128:143], v[168:171], v[112:115], v[128:143]
    v_mfma_f32_32x32x16_bf16 v[128:143], v[172:175], v[120:123], v[128:143]
    s_waitcnt lgkmcnt(8)
    v_mul_f32 v184, v64, v192
    v_mul_f32 v185, v65, v193
    v_fmac_f32 v184, v66, v194
    v_fmac_f32 v185, v67, v195
    v_fmac_f32 v184, v68, v196
    v_fmac_f32 v185, v69, v197
    v_fmac_f32 v184, v70, v198
    v_fmac_f32 v185, v71, v199
    v_fmac_f32 v184, v72, v200
    v_fmac_f32 v185, v73, v201
    v_fmac_f32 v184, v74, v202
    v_fmac_f32 v185, v75, v203
    v_fmac_f32 v184, v76, v204
    v_fmac_f32 v185, v77, v205
    v_fmac_f32 v184, v78, v206
    v_fmac_f32 v185, v79, v207
    v_fmac_f32 v184, v80, v208
    v_fmac_f32 v185, v81, v209
    v_fmac_f32 v184, v82, v210
    v_fmac_f32 v185, v83, v211
    v_fmac_f32 v184, v84, v212
    v_fmac_f32 v185, v85, v213
    v_fmac_f32 v184, v86, v214
    v_fmac_f32 v185, v87, v215
    v_fmac_f32 v184, v88, v228
    v_fmac_f32 v185, v89, v229
    v_fmac_f32 v184, v90, v230
    v_fmac_f32 v185, v91, v231
    v_fmac_f32 v184, v92, v248
    v_fmac_f32 v185, v93, v249
    v_fmac_f32 v184, v94, v250
    v_fmac_f32 v185, v95, v251
    v_add_f32 v184, v184, v185
    v_mov_b32 v185, v184
    v_mfma_f32_32x32x16_bf16 v[144:159], v[160:163], v[100:103], v[144:159]
    v_mfma_f32_32x32x16_bf16 v[144:159], v[164:167], v[108:111], v[144:159]
    v_mfma_f32_32x32x16_bf16 v[144:159], v[168:171], v[116:119], v[144:159]
    v_mfma_f32_32x32x16_bf16 v[144:159], v[172:175], v[124:127], v[144:159]
    v_permlane32_swap_b32 v184, v185
    v_lshlrev_b32 v11, 16, v11
    v_add_f32 v184, v184, v185
    v_add_f32 v11, v11, v184
    v_cvt_pk_bf16_f32 v11, v11, v11
    buffer_store_short v11, v10, s[32:35], 0 offen
    s_mov_b32 s54, 3216550459
    v_mul_f32 v176, s54, v128
    v_mul_f32 v177, s54, v130
    v_mul_f32 v178, s54, v132
    v_mul_f32 v179, s54, v134
    s_nop 0
    v_mul_f32 v180, s54, v144
    v_mul_f32 v181, s54, v146
    v_mul_f32 v182, s54, v148
    v_mul_f32 v183, s54, v150
    v_exp_f32 v176, v176
    v_exp_f32 v177, v177
    v_exp_f32 v178, v178
    v_exp_f32 v179, v179
    v_exp_f32 v180, v180
    v_exp_f32 v181, v181
    v_exp_f32 v182, v182
    v_exp_f32 v183, v183
    v_add_f32 v176, 1.0, v176
    v_add_f32 v177, 1.0, v177
    v_add_f32 v178, 1.0, v178
    v_add_f32 v179, 1.0, v179
    v_add_f32 v180, 1.0, v180
    v_add_f32 v181, 1.0, v181
    v_add_f32 v182, 1.0, v182
    v_add_f32 v183, 1.0, v183
    v_rcp_f32 v176, v176
    v_rcp_f32 v177, v177
    v_rcp_f32 v178, v178
    v_rcp_f32 v179, v179
    v_rcp_f32 v180, v180
    v_rcp_f32 v181, v181
    v_rcp_f32 v182, v182
    v_rcp_f32 v183, v183
    s_waitcnt lgkmcnt(0)
    v_lshlrev_b32 v232, 16, v232
    v_fma_f32 v176, v128, v176, v232
    v_cvt_pk_bf16_f32 v176, v176, v176
    v_lshlrev_b32 v233, 16, v233
    v_fma_f32 v177, v130, v177, v233
    v_cvt_pk_bf16_f32 v177, v177, v177
    v_lshlrev_b32 v234, 16, v234
    v_fma_f32 v178, v132, v178, v234
    v_cvt_pk_bf16_f32 v178, v178, v178
    v_lshlrev_b32 v236, 16, v236
    v_fma_f32 v179, v134, v179, v236
    v_cvt_pk_bf16_f32 v179, v179, v179
    v_lshlrev_b32 v237, 16, v237
    v_fma_f32 v180, v144, v180, v237
    v_cvt_pk_bf16_f32 v180, v180, v180
    v_lshlrev_b32 v238, 16, v238
    v_fma_f32 v181, v146, v181, v238
    v_cvt_pk_bf16_f32 v181, v181, v181
    v_lshlrev_b32 v252, 16, v252
    v_fma_f32 v182, v148, v182, v252
    v_cvt_pk_bf16_f32 v182, v182, v182
    v_lshlrev_b32 v253, 16, v253
    v_fma_f32 v183, v150, v183, v253
    v_cvt_pk_bf16_f32 v183, v183, v183
    ds_write_b16 v7, v176 offset:1024
    ds_write_b16 v7, v177 offset:1152
    ds_write_b16 v7, v178 offset:1536
    ds_write_b16 v7, v179 offset:1664
    ds_write_b16 v7, v180 offset:1088
    ds_write_b16 v7, v181 offset:1216
    ds_write_b16 v7, v182 offset:1600
    ds_write_b16 v7, v183 offset:1728
    v_lshlrev_b32 v6, 4, v1
    v_add_u32 v6, s62, v6
    ds_read_b128 v[48:51], v6 offset:1024
    s_waitcnt lgkmcnt(0)
    buffer_store_dwordx4 v[48:51], v[240:241], s[28:31], 0 idxen offen
    s_endpgm
L2_l1n:
    s_waitcnt lgkmcnt(0)
    v_exp_f32 v160, v128
    ds_read_b64_tr_b16 v[216:217], v235 offset:0
    v_exp_f32 v161, v129
    v_exp_f32 v162, v130
    ds_read_b64_tr_b16 v[218:219], v15 offset:0
    v_exp_f32 v163, v131
    v_exp_f32 v164, v132
    ds_read_b64_tr_b16 v[220:221], v235 offset:1024
    v_exp_f32 v165, v133
    v_exp_f32 v166, v134
    ds_read_b64_tr_b16 v[222:223], v15 offset:1024
    v_exp_f32 v167, v135
    v_exp_f32 v168, v136
    ds_write_b32 v254, v225
    v_exp_f32 v169, v137
    v_exp_f32 v170, v138
    v_exp_f32 v171, v139
    v_exp_f32 v172, v140
    v_exp_f32 v173, v141
    v_exp_f32 v174, v142
    v_exp_f32 v175, v143
    v_exp_f32 v176, v144
    v_exp_f32 v177, v145
    v_mfma_f32_32x32x16_bf16 v[160:175], v[224:227], v[224:227], v[160:175]
    v_exp_f32 v178, v146
    v_exp_f32 v179, v147
    v_exp_f32 v180, v148
    v_exp_f32 v181, v149
    v_exp_f32 v182, v150
    v_exp_f32 v183, v151
    v_exp_f32 v184, v152
    v_exp_f32 v185, v153
    v_exp_f32 v186, v154
    v_exp_f32 v187, v155
    v_exp_f32 v188, v156
    v_exp_f32 v189, v157
    v_exp_f32 v190, v158
    v_exp_f32 v191, v159
    v_rcp_f32 v160, v160
    v_rcp_f32 v161, v161
    v_mfma_f32_32x32x16_bf16 v[176:191], v[224:227], v[224:227], v[176:191]
    v_rcp_f32 v162, v162
    v_rcp_f32 v163, v163
    v_rcp_f32 v164, v164
    v_rcp_f32 v165, v165
    v_rcp_f32 v166, v166
    v_rcp_f32 v167, v167
    v_rcp_f32 v168, v168
    v_rcp_f32 v169, v169
    v_rcp_f32 v170, v170
    v_rcp_f32 v171, v171
    v_rcp_f32 v172, v172
    v_rcp_f32 v173, v173
    v_rcp_f32 v174, v174
    v_rcp_f32 v175, v175
    v_rcp_f32 v176, v176
    v_rcp_f32 v177, v177
    v_rcp_f32 v178, v178
    v_rcp_f32 v179, v179
    v_rcp_f32 v180, v180
    v_rcp_f32 v181, v181
    v_rcp_f32 v182, v182
    v_rcp_f32 v183, v183
    v_rcp_f32 v184, v184
    v_rcp_f32 v185, v185
    v_rcp_f32 v186, v186
    v_rcp_f32 v187, v187
    v_rcp_f32 v188, v188
    v_rcp_f32 v189, v189
    v_rcp_f32 v190, v190
    v_rcp_f32 v191, v191
    v_pk_mul_f32 v[160:161], v[160:161], v[128:129]
    v_pk_mul_f32 v[162:163], v[162:163], v[130:131]
    v_pk_mul_f32 v[164:165], v[164:165], v[132:133]
    v_pk_mul_f32 v[166:167], v[166:167], v[134:135]
    v_pk_mul_f32 v[168:169], v[168:169], v[136:137]
    v_pk_mul_f32 v[170:171], v[170:171], v[138:139]
    v_pk_mul_f32 v[172:173], v[172:173], v[140:141]
    v_pk_mul_f32 v[174:175], v[174:175], v[142:143]
    v_pk_mul_f32 v[176:177], v[176:177], v[144:145]
    v_pk_mul_f32 v[178:179], v[178:179], v[146:147]
    v_pk_mul_f32 v[180:181], v[180:181], v[148:149]
    v_pk_mul_f32 v[182:183], v[182:183], v[150:151]
    v_pk_mul_f32 v[184:185], v[184:185], v[152:153]
    v_pk_mul_f32 v[186:187], v[186:187], v[154:155]
    v_pk_mul_f32 v[188:189], v[188:189], v[156:157]
    v_pk_mul_f32 v[190:191], v[190:191], v[158:159]
    v_cvt_pk_bf16_f32 v128, v160, v161
    v_cvt_pk_bf16_f32 v129, v162, v163
    v_cvt_pk_bf16_f32 v130, v164, v165
    v_cvt_pk_bf16_f32 v131, v166, v167
    v_cvt_pk_bf16_f32 v132, v168, v169
    v_cvt_pk_bf16_f32 v133, v170, v171
    v_mfma_f32_32x32x16_bf16 v[64:79], v[128:131], v[216:219], v[64:79]
    v_cvt_pk_bf16_f32 v134, v172, v173
    v_cvt_pk_bf16_f32 v135, v174, v175
    v_cvt_pk_bf16_f32 v136, v176, v177
    v_cvt_pk_bf16_f32 v137, v178, v179
    v_mfma_f32_32x32x16_bf16 v[64:79], v[132:135], v[220:223], v[64:79]
    v_cvt_pk_bf16_f32 v138, v180, v181
    v_cvt_pk_bf16_f32 v139, v182, v183
    v_cvt_pk_bf16_f32 v140, v184, v185
    v_cvt_pk_bf16_f32 v141, v186, v187
    v_mfma_f32_32x32x16_bf16 v[80:95], v[136:139], v[216:219], v[80:95]
    v_cvt_pk_bf16_f32 v142, v188, v189
    v_cvt_pk_bf16_f32 v143, v190, v191
    s_nop 1
    v_mfma_f32_32x32x16_bf16 v[80:95], v[140:143], v[220:223], v[80:95]
    s_branch L2_nextbatch
L2_notiles:
    s_cmp_lt_u32 s47, 250
    s_cbranch_scc1 L2_nextbatch
    v_lshlrev_b32 v10, 4, v1
    v_add_u32 v9, 2048, v10
    buffer_load_dwordx4 v[16:19], v9, s[24:27], 0 offen
    v_add_u32 v9, 3072, v10
    buffer_load_dwordx4 v[20:23], v9, s[24:27], 0 offen
    v_add_u32 v9, 4096, v10
    buffer_load_dwordx4 v[24:27], v9, s[24:27], 0 offen
    v_add_u32 v9, 5120, v10
    buffer_load_dwordx4 v[28:31], v9, s[24:27], 0 offen
    v_add_u32 v9, 6144, v10
    buffer_load_dwordx4 v[32:35], v9, s[24:27], 0 offen
    v_add_u32 v9, 7168, v10
    buffer_load_dwordx4 v[36:39], v9, s[24:27], 0 offen
    v_add_u32 v9, 8192, v10
    buffer_load_dwordx4 v[40:43], v9, s[24:27], 0 offen
    v_add_u32 v9, 9216, v10
    buffer_load_dwordx4 v[44:47], v9, s[24:27], 0 offen
    v_add_u32 v9, 10240, v10
    buffer_load_dwordx4 v[128:131], v9, s[24:27], 0 offen
    v_add_u32 v9, 11264, v10
    buffer_load_dwordx4 v[132:135], v9, s[24:27], 0 offen
    v_add_u32 v9, 12288, v10
    buffer_load_dwordx4 v[136:139], v9, s[24:27], 0 offen
    v_add_u32 v9, 13312, v10
    buffer_load_dwordx4 v[140:143], v9, s[24:27], 0 offen
    v_add_u32 v9, 14336, v10
    buffer_load_dwordx4 v[144:147], v9, s[24:27], 0 offen
    v_add_u32 v9, 15360, v10
    buffer_load_dwordx4 v[148:151], v9, s[24:27], 0 offen
    v_add_u32 v9, 16384, v10
    buffer_load_dwordx4 v[152:155], v9, s[24:27], 0 offen
    v_add_u32 v9, 17408, v10
    buffer_load_dwordx4 v[156:159], v9, s[24:27], 0 offen
    v_lshrrev_b32 v9, 3, v1
    v_lshlrev_b32 v9, 3, v9
    v_add_u32 v3, s101, v9
    v_add_u32 v9, s53, v9
    v_cmp_gt_u32 vcc, 49, v3
    v_mov_b32 v4, -1
    v_and_b32 v241, 7, v1
    v_lshlrev_b32 v241, 4, v241
    v_cndmask_b32 v240, v4, v9, vcc
    v_bfe_u32 v9, v1, 1, 3
    v_lshlrev_b32 v9, 3, v9
    v_add_u32 v3, s101, v9
    v_add_u32 v9, s53, v9
    v_bfe_u32 v5, v1, 4, 1
    v_and_b32 v8, 1, v1
    v_lshl_add_u32 v5, v5, 1, v8
    v_cmp_gt_u32 vcc, 49, v3
    v_subrev_u32 v5, 1, v5
    v_cmp_gt_u32 s[56:57], 3, v5
    v_mul_u32_u24 v9, 6, v9
    s_and_b64 vcc, vcc, s[56:57]
    v_cmp_gt_u32 s[56:57], 32, v1
    v_lshl_add_u32 v9, v5, 1, v9
    v_mov_b32 v4, 0x7fffff00
    s_and_b64 vcc, vcc, s[56:57]
    v_cndmask_b32 v10, v4, v9, vcc
    buffer_load_ushort v11, v10, s[20:23], 0 offen
    s_waitcnt lgkmcnt(0)
    s_lshl_b32 s62, s3, 11
    s_add_u32 s62, s62, 50432
    s_mov_b32 m0, s62
    s_nop 0
    buffer_load_dwordx4 v[240:241], s[4:7], 0 idxen offen lds
    v_and_b32 v3, 31, v1
    v_lshrrev_b32 v4, 5, v1
    v_bfe_u32 v5, v1, 1, 3
    v_lshlrev_b32 v5, 7, v5
    v_lshl_add_u32 v5, v4, 4, v5
    v_add_u32 v5, s62, v5
    v_lshlrev_b32 v6, 7, v4
    v_add_u32 v6, 160512, v6
    v_lshlrev_b32 v7, 1, v3
    v_lshl_add_u32 v7, v4, 8, v7
    v_add_u32 v7, s62, v7
    s_mov_b32 s54, 3207688728
    s_mov_b32 s55, s54
    s_waitcnt vmcnt(0)
    ds_read_b128 v[48:51], v5 offset:0
    ds_read_b128 v[52:55], v5 offset:32
    ds_read_b128 v[56:59], v5 offset:64
    ds_read_b128 v[60:63], v5 offset:96
    ds_read_b128 v[192:195], v6 offset:0
    ds_read_b128 v[196:199], v6 offset:16
    ds_read_b128 v[200:203], v6 offset:32
    ds_read_b128 v[204:207], v6 offset:48
    ds_read_b128 v[208:211], v6 offset:64
    ds_read_b128 v[212:215], v6 offset:80
    ds_read_b128 v[228:231], v6 offset:96
    ds_read_b128 v[248:251], v6 offset:112
    v_pk_mul_f32 v[64:65], v[64:65], s[54:55]
    v_pk_mul_f32 v[66:67], v[66:67], s[54:55]
    v_pk_mul_f32 v[68:69], v[68:69], s[54:55]
    v_pk_mul_f32 v[70:71], v[70:71], s[54:55]
    v_pk_mul_f32 v[72:73], v[72:73], s[54:55]
    v_pk_mul_f32 v[74:75], v[74:75], s[54:55]
    v_pk_mul_f32 v[76:77], v[76:77], s[54:55]
    v_pk_mul_f32 v[78:79], v[78:79], s[54:55]
    v_pk_mul_f32 v[80:81], v[80:81], s[54:55]
    v_pk_mul_f32 v[82:83], v[82:83], s[54:55]
    v_pk_mul_f32 v[84:85], v[84:85], s[54:55]
    v_pk_mul_f32 v[86:87], v[86:87], s[54:55]
    v_pk_mul_f32 v[88:89], v[88:89], s[54:55]
    v_pk_mul_f32 v[90:91], v[90:91], s[54:55]
    v_pk_mul_f32 v[92:93], v[92:93], s[54:55]
    v_pk_mul_f32 v[94:95], v[94:95], s[54:55]
    s_waitcnt lgkmcnt(8)
    v_mfma_f32_32x32x16_bf16 v[96:111], v[48:51], v[16:19], 0
    v_mfma_f32_32x32x16_bf16 v[96:111], v[52:55], v[24:27], v[96:111]
    v_mfma_f32_32x32x16_bf16 v[96:111], v[56:59], v[32:35], v[96:111]
    v_mfma_f32_32x32x16_bf16 v[96:111], v[60:63], v[40:43], v[96:111]
    v_cvt_pk_bf16_f32 v160, v64, v65
    v_cvt_pk_bf16_f32 v161, v66, v67
    v_cvt_pk_bf16_f32 v162, v68, v69
    v_cvt_pk_bf16_f32 v163, v70, v71
    v_cvt_pk_bf16_f32 v164, v72, v73
    v_cvt_pk_bf16_f32 v165, v74, v75
    v_cvt_pk_bf16_f32 v166, v76, v77
    v_cvt_pk_bf16_f32 v167, v78, v79
    v_cvt_pk_bf16_f32 v168, v80, v81
    v_cvt_pk_bf16_f32 v169, v82, v83
    v_cvt_pk_bf16_f32 v170, v84, v85
    v_cvt_pk_bf16_f32 v171, v86, v87
    v_cvt_pk_bf16_f32 v172, v88, v89
    v_cvt_pk_bf16_f32 v173, v90, v91
    v_cvt_pk_bf16_f32 v174, v92, v93
    v_cvt_pk_bf16_f32 v175, v94, v95
    v_mfma_f32_32x32x16_bf16 v[112:127], v[48:51], v[20:23], 0
    v_mfma_f32_32x32x16_bf16 v[112:127], v[52:55], v[28:31], v[112:127]
    v_mfma_f32_32x32x16_bf16 v[112:127], v[56:59], v[36:39], v[112:127]
    v_mfma_f32_32x32x16_bf16 v[112:127], v[60:63], v[44:47], v[112:127]
    ds_read_u16 v232, v7 offset:0
    ds_read_u16 v233, v7 offset:128
    ds_read_u16 v234, v7 offset:512
    ds_read_u16 v236, v7 offset:640
    ds_read_u16 v237, v7 offset:64
    ds_read_u16 v238, v7 offset:192
    ds_read_u16 v252, v7 offset:576
    ds_read_u16 v253, v7 offset:704
    v_mfma_f32_32x32x16_bf16 v[96:111], v[160:163], v[128:131], v[96:111]
    v_mfma_f32_32x32x16_bf16 v[96:111], v[164:167], v[136:139], v[96:111]
    v_mfma_f32_32x32x16_bf16 v[96:111], v[168:171], v[144:147], v[96:111]
    v_mfma_f32_32x32x16_bf16 v[96:111], v[172:175], v[152:155], v[96:111]
    s_waitcnt lgkmcnt(8)
    v_mul_f32 v184, v64, v192
    v_mul_f32 v185, v65, v193
    v_fmac_f32 v184, v66, v194
    v_fmac_f32 v185, v67, v195
    v_fmac_f32 v184, v68, v196
    v_fmac_f32 v185, v69, v197
    v_fmac_f32 v184, v70, v198
    v_fmac_f32 v185, v71, v199
    v_fmac_f32 v184, v72, v200
    v_fmac_f32 v185, v73, v201
    v_fmac_f32 v184, v74, v202
    v_fmac_f32 v185, v75, v203
    v_fmac_f32 v184, v76, v204
    v_fmac_f32 v185, v77, v205
    v_fmac_f32 v184, v78, v206
    v_fmac_f32 v185, v79, v207
    v_fmac_f32 v184, v80, v208
    v_fmac_f32 v185, v81, v209
    v_fmac_f32 v184, v82, v210
    v_fmac_f32 v185, v83, v211
    v_fmac_f32 v184, v84, v212
    v_fmac_f32 v185, v85, v213
    v_fmac_f32 v184, v86, v214
    v_fmac_f32 v185, v87, v215
    v_fmac_f32 v184, v88, v228
    v_fmac_f32 v185, v89, v229
    v_fmac_f32 v184, v90, v230
    v_fmac_f32 v185, v91, v231
    v_fmac_f32 v184, v92, v248
    v_fmac_f32 v185, v93, v249
    v_fmac_f32 v184, v94, v250
    v_fmac_f32 v185, v95, v251
    v_add_f32 v184, v184, v185
    v_mov_b32 v185, v184
    v_mfma_f32_32x32x16_bf16 v[112:127], v[160:163], v[132:135], v[112:127]
    v_mfma_f32_32x32x16_bf16 v[112:127], v[164:167], v[140:143], v[112:127]
    v_mfma_f32_32x32x16_bf16 v[112:127], v[168:171], v[148:151], v[112:127]
    v_mfma_f32_32x32x16_bf16 v[112:127], v[172:175], v[156:159], v[112:127]
    v_permlane32_swap_b32 v184, v185
    v_lshlrev_b32 v11, 16, v11
    v_add_f32 v184, v184, v185
    v_add_f32 v11, v11, v184
    v_cvt_pk_bf16_f32 v11, v11, v11
    buffer_store_short v11, v10, s[32:35], 0 offen
    s_mov_b32 s54, 3216550459
    v_mul_f32 v176, s54, v96
    v_mul_f32 v177, s54, v98
    v_mul_f32 v178, s54, v100
    v_mul_f32 v179, s54, v102
    s_nop 0
    v_mul_f32 v180, s54, v112
    v_mul_f32 v181, s54, v114
    v_mul_f32 v182, s54, v116
    v_mul_f32 v183, s54, v118
    v_exp_f32 v176, v176
    v_exp_f32 v177, v177
    v_exp_f32 v178, v178
    v_exp_f32 v179, v179
    v_exp_f32 v180, v180
    v_exp_f32 v181, v181
    v_exp_f32 v182, v182
    v_exp_f32 v183, v183
    v_add_f32 v176, 1.0, v176
    v_add_f32 v177, 1.0, v177
    v_add_f32 v178, 1.0, v178
    v_add_f32 v179, 1.0, v179
    v_add_f32 v180, 1.0, v180
    v_add_f32 v181, 1.0, v181
    v_add_f32 v182, 1.0, v182
    v_add_f32 v183, 1.0, v183
    v_rcp_f32 v176, v176
    v_rcp_f32 v177, v177
    v_rcp_f32 v178, v178
    v_rcp_f32 v179, v179
    v_rcp_f32 v180, v180
    v_rcp_f32 v181, v181
    v_rcp_f32 v182, v182
    v_rcp_f32 v183, v183
    s_waitcnt lgkmcnt(0)
    v_lshlrev_b32 v232, 16, v232
    v_fma_f32 v176, v96, v176, v232
    v_cvt_pk_bf16_f32 v176, v176, v176
    v_lshlrev_b32 v233, 16, v233
    v_fma_f32 v177, v98, v177, v233
    v_cvt_pk_bf16_f32 v177, v177, v177
    v_lshlrev_b32 v234, 16, v234
    v_fma_f32 v178, v100, v178, v234
    v_cvt_pk_bf16_f32 v178, v178, v178
    v_lshlrev_b32 v236, 16, v236
    v_fma_f32 v179, v102, v179, v236
    v_cvt_pk_bf16_f32 v179, v179, v179
    v_lshlrev_b32 v237, 16, v237
    v_fma_f32 v180, v112, v180, v237
    v_cvt_pk_bf16_f32 v180, v180, v180
    v_lshlrev_b32 v238, 16, v238
    v_fma_f32 v181, v114, v181, v238
    v_cvt_pk_bf16_f32 v181, v181, v181
    v_lshlrev_b32 v252, 16, v252
    v_fma_f32 v182, v116, v182, v252
    v_cvt_pk_bf16_f32 v182, v182, v182
    v_lshlrev_b32 v253, 16, v253
    v_fma_f32 v183, v118, v183, v253
    v_cvt_pk_bf16_f32 v183, v183, v183
    ds_write_b16 v7, v176 offset:1024
    ds_write_b16 v7, v177 offset:1152
    ds_write_b16 v7, v178 offset:1536
    ds_write_b16 v7, v179 offset:1664
    ds_write_b16 v7, v180 offset:1088
    ds_write_b16 v7, v181 offset:1216
    ds_write_b16 v7, v182 offset:1600
    ds_write_b16 v7, v183 offset:1728
    v_lshlrev_b32 v6, 4, v1
    v_add_u32 v6, s62, v6
    ds_read_b128 v[48:51], v6 offset:1024
    s_waitcnt lgkmcnt(0)
    buffer_store_dwordx4 v[48:51], v[240:241], s[28:31], 0 idxen offen
    s_endpgm
L2_nextbatch:
    s_waitcnt vmcnt(0) lgkmcnt(0)
    s_mov_b32 s46, s47
    s_add_u32 s47, s47, 1
    s_branch L2_batch
L2_end:
    s_endpgm
.section .rodata,"a"
.p2align 6
.amdhsa_kernel egnn_part_kernel
  .amdhsa_next_free_vgpr 96
  .amdhsa_next_free_sgpr 40
  .amdhsa_accum_offset 96
  .amdhsa_group_segment_fixed_size 0
  .amdhsa_kernarg_size 88
  .amdhsa_user_sgpr_count 2
  .amdhsa_user_sgpr_kernarg_segment_ptr 1
  .amdhsa_system_sgpr_workgroup_id_x 1
  .amdhsa_float_denorm_mode_32 3
.end_amdhsa_kernel
.p2align 6
.amdhsa_kernel egnn_main_kernel
  .amdhsa_next_free_vgpr 256
  .amdhsa_next_free_sgpr 102
  .amdhsa_accum_offset 256
  .amdhsa_group_segment_fixed_size 0
  .amdhsa_kernarg_size 88
  .amdhsa_user_sgpr_count 2
  .amdhsa_user_sgpr_kernarg_segment_ptr 1
  .amdhsa_system_sgpr_workgroup_id_x 1
  .amdhsa_float_denorm_mode_32 3
.end_amdhsa_kernel
```
